```python
import torch

def _softmax(x, axis=-1):
    return torch.softmax(x, dim=axis)

def _gelu(x):
    return torch.nn.functional.gelu(x, approximate='tanh')

def _silu(x):
    return torch.nn.functional.silu(x)

def _sigmoid(x):
    return torch.sigmoid(x)

def _layernorm(x, axis=-1, eps=1e-05):
    m = x.mean(dim=axis, keepdim=True)
    v = x.var(dim=axis, keepdim=True, unbiased=False)
    return (x - m) / torch.sqrt(v + eps)

def _scatter_add(tgt, idx, src, axis=0):
    return tgt.clone().index_add_(axis, idx, src)

def _segment_sum(src, seg, n):
    out = torch.zeros((n,) + src.shape[1:], dtype=src.dtype)
    return out.index_add_(0, seg, src)

def _pad(x, pw):
    flat = tuple((v for pair in reversed(pw) for v in pair))
    return torch.nn.functional.pad(x, flat)
kernel_name = 'standalone__molecular_angular_painn__graph'

def setup_inputs():

    _w = lambda a: (lambda t: t.to(torch.bfloat16) if t.is_floating_point() else t)(torch.as_tensor(a))
    N, deg, D = (25000, 32, 64)
    n_rbf = max(16, 4)
    E = N * deg
    cutoff = 5.0
    freqs = (torch.arange(1, n_rbf + 1) * torch.pi / cutoff).to(float)
    return {'sv': _w((lambda *s: torch.randn(*s, dtype=torch.bfloat16) * 0.4)(N, 4, D) * 0.3), 'pos': _w((lambda *s: torch.randn(*s, dtype=torch.bfloat16) * 1.6)(N, 3) * 1.2), 'src': _w((lambda lo, hi, *s: torch.randint(lo, hi, s))(0, N, E).to(torch.int64)), 'dst': _w((lambda lo, hi, *s: torch.randint(lo, hi, s))(0, N, E).to(torch.int64)), 'freqs': _w(freqs), 'w_phi1': _w((lambda *s: torch.randn(*s, dtype=torch.bfloat16) * 3.2)(D, D) / D ** 0.5), 'w_phi2': _w((lambda *s: torch.randn(*s, dtype=torch.bfloat16) * 1.6)(D, 3 * D) / D ** 0.5), 'w_rbf': _w((lambda *s: torch.randn(*s, dtype=torch.bfloat16) * 1.6)(n_rbf, 3 * D) / n_rbf ** 0.5)}

def reference(sv, pos, src, dst, freqs, w_phi1, w_phi2, w_rbf):
    N, _, D = sv.shape
    E = src.shape[0]
    PI, cutoff = (3.141592653589793, 5.0)
    s, v = (sv[:, 0, :].clone(), sv[:, 1:, :].clone())
    r_vec = pos[src] - pos[dst]
    d = torch.sqrt((r_vec * r_vec).sum(-1) + 1e-08)
    r_hat = r_vec / d[:, None]
    rbf = torch.sin(d[:, None] * freqs[None, :]) / d[:, None]
    fcut = 0.5 * (torch.cos(PI * d / cutoff) + 1.0)
    fcut = torch.where(d < cutoff, fcut, 0.0 * d)
    Wf = rbf @ w_rbf * fcut[:, None]
    phi = (_silu(s @ w_phi1) @ w_phi2)[src]
    m = phi * Wf
    m_s, m_vv, m_vr = (m[:, :D].clone(), m[:, D:2 * D].clone(), m[:, 2 * D:].clone())
    ds = _segment_sum(m_s, dst, N)
    dv_e = m_vv[:, None, :] * v[src] + m_vr[:, None, :] * r_hat[:, :, None]
    dv = _segment_sum(dv_e.reshape(E, 3 * D), dst, N).reshape(N, 3, D)
    return sv + torch.concatenate([ds[:, None, :], dv], axis=1)
```

```asm
; @launch kernel=painn_prep_kernel grid=(256,1,1) block=(1024,1,1) lds=152576
; @launch kernel=painn_main_kernel grid=(256,1,1) block=(512,1,1) lds=163840
.amdgcn_target "amdgcn-amd-amdhsa--gfx950"
.text
.globl painn_prep_kernel
.p2align 8
.type painn_prep_kernel,@function
painn_prep_kernel:
    s_cmp_ge_u32 s2, 256
    s_cbranch_scc1 K1_END
    s_load_dwordx16 s[16:31], s[0:1], 0
    s_load_dwordx2 s[32:33], s[0:1], 80
    v_lshrrev_b32 v1, 6, v0
    v_and_b32 v2, 63, v0
    v_readfirstlane_b32 s3, v1
    s_mov_b32 s4, 0xffff0000
    s_cmp_lg_u32 s3, 15
    s_cbranch_scc1 K1_NOCT
    s_getpc_b64 s[74:75]
K1_PC:
    s_add_u32 s74, s74, painn_prep_kernel-K1_PC
    s_addc_u32 s75, s75, -1
    s_lshr_b32 s76, s2, 3
    s_mul_i32 s76, s76, 1024
    v_and_b32 v127, 63, v0
    v_lshlrev_b32 v127, 7, v127
    v_add_u32 v127, s76, v127
    v_min_u32 v127, K2_END-painn_prep_kernel, v127
    s_mov_b64 exec, 0xff
    global_load_dword v127, v127, s[74:75]
    s_mov_b64 exec, -1
K1_NOCT:
    s_cmp_ge_u32 s2, 250
    s_cbranch_scc1 K1_GTAB
    s_cmp_ge_u32 s2, 125
    s_cbranch_scc1 K1_NODE
    v_lshlrev_b32 v1, 2, v0
    v_lshlrev_b32 v2, 4, v2
    s_mul_i32 s5, s2, 25600
    s_lshr_b32 s8, s2, 3
    s_mul_i32 s8, s8, 9
    s_add_u32 s8, s8, s3
    s_lshl_b32 s8, s8, 10
    s_waitcnt lgkmcnt(0)
    s_mov_b32 s40, s20
    s_mov_b32 s41, s21
    s_mov_b32 s42, 3200000
    s_mov_b32 s43, 0x20000
    s_mov_b32 s44, s22
    s_mov_b32 s45, s23
    s_mov_b32 s46, 3200000
    s_mov_b32 s47, 0x20000
    s_mov_b32 s36, s18
    s_mov_b32 s37, s19
    s_mov_b32 s38, 150000
    s_mov_b32 s39, 0x20000
    s_add_u32 s40, s40, s5
    s_addc_u32 s41, s41, 0
    s_mov_b32 s42, 25600
    s_add_u32 s44, s44, s5
    s_addc_u32 s45, s45, 0
    s_mov_b32 s46, 25600
    s_sub_u32 s11, s8, 150528
    s_cselect_b32 s8, s8, s11
    s_add_u32 m0, s8, 2048
    s_nop 0
    buffer_load_dwordx4 v2, s[36:39], s8 offen lds
    s_add_u32 s8, s8, 16384
    s_sub_u32 s11, s8, 150528
    s_cselect_b32 s8, s8, s11
    s_add_u32 m0, s8, 2048
    s_nop 0
    buffer_load_dwordx4 v2, s[36:39], s8 offen lds
    s_add_u32 s8, s8, 16384
    s_sub_u32 s11, s8, 150528
    s_cselect_b32 s8, s8, s11
    s_add_u32 m0, s8, 2048
    s_nop 0
    buffer_load_dwordx4 v2, s[36:39], s8 offen lds
    s_add_u32 s8, s8, 16384
    s_sub_u32 s11, s8, 150528
    s_cselect_b32 s8, s8, s11
    s_add_u32 m0, s8, 2048
    s_nop 0
    buffer_load_dwordx4 v2, s[36:39], s8 offen lds
    s_add_u32 s8, s8, 16384
    s_sub_u32 s11, s8, 150528
    s_cselect_b32 s8, s8, s11
    s_add_u32 m0, s8, 2048
    s_nop 0
    buffer_load_dwordx4 v2, s[36:39], s8 offen lds
    s_add_u32 s8, s8, 16384
    s_sub_u32 s11, s8, 150528
    s_cselect_b32 s8, s8, s11
    s_add_u32 m0, s8, 2048
    s_nop 0
    buffer_load_dwordx4 v2, s[36:39], s8 offen lds
    s_add_u32 s8, s8, 16384
    s_sub_u32 s11, s8, 150528
    s_cselect_b32 s8, s8, s11
    s_add_u32 m0, s8, 2048
    s_nop 0
    buffer_load_dwordx4 v2, s[36:39], s8 offen lds
    s_add_u32 s8, s8, 16384
    s_sub_u32 s11, s8, 150528
    s_cselect_b32 s8, s8, s11
    s_add_u32 m0, s8, 2048
    s_nop 0
    buffer_load_dwordx4 v2, s[36:39], s8 offen lds
    s_add_u32 s8, s8, 16384
    s_sub_u32 s11, s8, 150528
    s_cselect_b32 s8, s8, s11
    s_add_u32 m0, s8, 2048
    s_nop 0
    buffer_load_dwordx4 v2, s[36:39], s8 offen lds
    s_add_u32 s8, s8, 16384
    s_cmp_ge_u32 s3, 3
    s_cbranch_scc1 K1_DMADONE
    s_sub_u32 s11, s8, 150528
    s_cselect_b32 s8, s8, s11
    s_add_u32 m0, s8, 2048
    s_nop 0
    buffer_load_dwordx4 v2, s[36:39], s8 offen lds
    s_add_u32 s8, s8, 16384
K1_DMADONE:
    s_barrier
    buffer_load_dword v4, v1, s[40:43], 0 offen nt
    buffer_load_dword v11, v1, s[44:47], 0 offen nt
    v_add_u32 v1, 4096, v1
    buffer_load_dword v5, v1, s[40:43], 0 offen nt
    buffer_load_dword v12, v1, s[44:47], 0 offen nt
    v_add_u32 v1, 4096, v1
    buffer_load_dword v6, v1, s[40:43], 0 offen nt
    buffer_load_dword v13, v1, s[44:47], 0 offen nt
    v_add_u32 v1, 4096, v1
    buffer_load_dword v7, v1, s[40:43], 0 offen nt
    buffer_load_dword v14, v1, s[44:47], 0 offen nt
    v_add_u32 v1, 4096, v1
    s_add_u32 s48, s32, 16000000
    s_addc_u32 s49, s33, 0
    s_mov_b32 s50, 9600000
    s_mov_b32 s51, 0x20000
    s_add_u32 s52, s32, 25600000
    s_addc_u32 s53, s33, 0
    s_mov_b32 s54, 128000
    s_mov_b32 s55, 0x20000
    v_mov_b32 v20, 0
    v_mov_b32 v21, 0
    v_mov_b32 v22, 0
    v_mov_b32 v23, 0
    v_mov_b32 v24, 0
    v_mov_b32 v25, 0
    v_mov_b32 v26, 0
    v_mov_b32 v27, 0
    v_mov_b32 v28, 0
    v_mov_b32 v29, 0
    v_mov_b32 v30, 0
    v_mov_b32 v31, 0
    v_mov_b32 v32, 0
    v_mov_b32 v33, 0
    v_mov_b32 v34, 0
    v_mov_b32 v35, 0
    v_mov_b32 v36, 0
    v_mov_b32 v37, 0
    v_mov_b32 v38, 0
    v_mov_b32 v39, 0
    v_mov_b32 v40, 0
    v_mov_b32 v41, 0
    v_mov_b32 v42, 0
    v_mov_b32 v43, 0
    v_mov_b32 v44, 0
    v_mov_b32 v45, 0
    v_mov_b32 v46, 0
    v_mov_b32 v47, 0
    v_mov_b32 v48, 0
    v_mov_b32 v49, 0
    v_mov_b32 v50, 0
    v_mov_b32 v51, 0
    v_mov_b32 v52, 0
    v_mov_b32 v53, 0
    v_mov_b32 v54, 0
    v_mov_b32 v55, 0
    v_mov_b32 v56, 0
    v_mov_b32 v57, 0
    v_mov_b32 v58, 0
    v_mov_b32 v59, 0
    v_mov_b32 v60, 0
    v_mov_b32 v61, 0
    s_cmp_lg_u32 s3, 0
    s_cbranch_scc1 K1E_NOZ
    ds_write_b128 v2, v[20:23] offset:0
K1E_NOZ:
    v_mov_b32 v3, 1
    v_mov_b32 v98, 0
    v_mov_b32 v91, 0
    s_mov_b32 s9, 0x409c0000
    s_mov_b32 s10, -98
    s_mov_b32 s11, 0xffff
    s_mov_b32 s14, 0xf8000000
    v_mov_b32 v100, 0xffff409d
    v_mov_b32 v101, 2048
    v_mov_b32 v102, 0x0202
    v_mov_b32 v103, 0x0100
    v_mov_b32 v104, 0x0c0c
    s_waitcnt vmcnt(8) lgkmcnt(0)
    s_barrier
    buffer_load_dword v8, v1, s[40:43], 0 offen nt
    buffer_load_dword v15, v1, s[44:47], 0 offen nt
    v_add_u32 v1, 4096, v1
    buffer_load_dword v9, v1, s[40:43], 0 offen nt
    buffer_load_dword v16, v1, s[44:47], 0 offen nt
    v_add_u32 v1, 4096, v1
    buffer_load_dword v10, v1, s[40:43], 0 offen nt
    buffer_load_dword v17, v1, s[44:47], 0 offen nt
    v_add_u32 v1, 4096, v1
    s_waitcnt vmcnt(10)
    v_mul_u32_u24 v106, 6, v4
    ds_read_u16_d16_hi v20, v106 offset:2048
    ds_read_u16_d16_hi v21, v106 offset:2050
    ds_read_u16_d16_hi v22, v106 offset:2052
    v_mul_u32_u24 v107, 6, v11
    ds_read_u16_d16_hi v23, v107 offset:2048
    ds_read_u16_d16_hi v24, v107 offset:2050
    ds_read_u16_d16_hi v25, v107 offset:2052
    v_mul_u32_u24 v67, 2675, v11
    v_lshrrev_b32 v67, 18, v67
    v_mad_i32_i24 v106, v67, s10, v11
    v_lshlrev_b32 v67, 2, v67
    v_mul_u32_u24 v107, 171795, v4
    v_and_or_b32 v64, v107, s14, v4
    v_lshl_or_b32 v64, v106, 18, v64
    v_mul_u32_u24 v106, 6, v5
    ds_read_u16_d16_hi v26, v106 offset:2048
    ds_read_u16_d16_hi v27, v106 offset:2050
    ds_read_u16_d16_hi v28, v106 offset:2052
    v_mul_u32_u24 v107, 6, v12
    ds_read_u16_d16_hi v29, v107 offset:2048
    ds_read_u16_d16_hi v30, v107 offset:2050
    ds_read_u16_d16_hi v31, v107 offset:2052
    v_mul_u32_u24 v71, 2675, v12
    v_lshrrev_b32 v71, 18, v71
    v_mad_i32_i24 v106, v71, s10, v12
    v_lshlrev_b32 v71, 2, v71
    v_mul_u32_u24 v107, 171795, v5
    v_and_or_b32 v68, v107, s14, v5
    v_lshl_or_b32 v68, v106, 18, v68
    s_waitcnt vmcnt(6) lgkmcnt(0)
    v_mul_u32_u24 v106, 6, v6
    ds_read_u16_d16_hi v32, v106 offset:2048
    ds_read_u16_d16_hi v33, v106 offset:2050
    ds_read_u16_d16_hi v34, v106 offset:2052
    v_mul_u32_u24 v107, 6, v13
    ds_read_u16_d16_hi v35, v107 offset:2048
    ds_read_u16_d16_hi v36, v107 offset:2050
    ds_read_u16_d16_hi v37, v107 offset:2052
    v_mul_u32_u24 v75, 2675, v13
    v_lshrrev_b32 v75, 18, v75
    v_mad_i32_i24 v106, v75, s10, v13
    v_lshlrev_b32 v75, 2, v75
    v_mul_u32_u24 v107, 171795, v6
    v_and_or_b32 v72, v107, s14, v6
    v_lshl_or_b32 v72, v106, 18, v72
    v_mul_u32_u24 v106, 6, v7
    ds_read_u16_d16_hi v38, v106 offset:2048
    ds_read_u16_d16_hi v39, v106 offset:2050
    ds_read_u16_d16_hi v40, v106 offset:2052
    v_mul_u32_u24 v107, 6, v14
    ds_read_u16_d16_hi v41, v107 offset:2048
    ds_read_u16_d16_hi v42, v107 offset:2050
    ds_read_u16_d16_hi v43, v107 offset:2052
    v_mul_u32_u24 v79, 2675, v14
    v_lshrrev_b32 v79, 18, v79
    v_mad_i32_i24 v106, v79, s10, v14
    v_lshlrev_b32 v79, 2, v79
    v_mul_u32_u24 v107, 171795, v7
    v_and_or_b32 v76, v107, s14, v7
    v_lshl_or_b32 v76, v106, 18, v76
    v_sub_f32 v20, v20, v23
    v_sub_f32 v21, v21, v24
    v_sub_f32 v22, v22, v25
    v_sub_f32 v26, v26, v29
    v_sub_f32 v27, v27, v30
    v_sub_f32 v28, v28, v31
    v_cvt_pk_bf16_f32 v108, v20, v21
    v_cvt_pk_bf16_f32 v109, v26, v27
    v_cvt_pk_bf16_f32 v110, v22, v28
    v_lshlrev_b32 v20, 16, v108
    v_and_b32 v21, s4, v108
    v_lshlrev_b32 v26, 16, v109
    v_and_b32 v27, s4, v109
    v_lshlrev_b32 v22, 16, v110
    v_and_b32 v28, s4, v110
    v_mul_f32 v23, v20, v20
    v_mul_f32 v24, v21, v21
    v_mul_f32 v25, v22, v22
    v_mul_f32 v29, v26, v26
    v_mul_f32 v30, v27, v27
    v_mul_f32 v31, v28, v28
    v_cvt_pk_bf16_f32 v108, v23, v24
    v_cvt_pk_bf16_f32 v109, v29, v30
    v_cvt_pk_bf16_f32 v110, v25, v31
    v_lshlrev_b32 v23, 16, v108
    v_and_b32 v24, s4, v108
    v_lshlrev_b32 v29, 16, v109
    v_and_b32 v30, s4, v109
    v_lshlrev_b32 v25, 16, v110
    v_and_b32 v31, s4, v110
    v_add_f32 v23, v23, v24
    v_add_f32 v29, v29, v30
    v_add_f32 v23, v23, v25
    v_add_f32 v29, v29, v31
    v_cvt_pk_bf16_f32 v110, v23, v29
    v_lshlrev_b32 v23, 16, v110
    v_and_b32 v29, s4, v110
    v_add_f32 v23, 0x322bcc77, v23
    v_add_f32 v29, 0x322bcc77, v29
    v_cvt_pk_bf16_f32 v110, v23, v29
    v_lshlrev_b32 v23, 16, v110
    v_and_b32 v29, s4, v110
    v_sqrt_f32 v23, v23
    v_sqrt_f32 v29, v29
    s_nop 0
    v_cvt_pk_bf16_f32 v110, v23, v29
    v_lshlrev_b32 v23, 16, v110
    v_and_b32 v29, s4, v110
    v_cmp_ge_u32 s[60:61], s9, v23
    v_cmp_ge_u32 s[62:63], s9, v29
    v_rcp_f32 v24, v23
    v_rcp_f32 v30, v29
    s_mov_b64 exec, s[60:61]
    ds_add_rtn_u32 v92, v67, v3 offset:0
    s_mov_b64 exec, s[62:63]
    ds_add_rtn_u32 v93, v71, v3 offset:0
    s_mov_b64 exec, -1
    v_mul_f32 v20, v20, v24
    v_mul_f32 v21, v21, v24
    v_mul_f32 v22, v22, v24
    v_cvt_pk_bf16_f32 v66, v21, v22
    v_cvt_pk_bf16_f32 v65, v23, v20
    v_xad_u32 v65, v65, s11, v100
    v_mul_f32 v26, v26, v30
    v_mul_f32 v27, v27, v30
    v_mul_f32 v28, v28, v30
    v_cvt_pk_bf16_f32 v70, v27, v28
    v_cvt_pk_bf16_f32 v69, v29, v26
    v_xad_u32 v69, v69, s11, v100
    s_waitcnt vmcnt(2) lgkmcnt(0)
    v_mul_u32_u24 v106, 6, v8
    ds_read_u16_d16_hi v44, v106 offset:2048
    ds_read_u16_d16_hi v45, v106 offset:2050
    ds_read_u16_d16_hi v46, v106 offset:2052
    v_mul_u32_u24 v107, 6, v15
    ds_read_u16_d16_hi v47, v107 offset:2048
    ds_read_u16_d16_hi v48, v107 offset:2050
    ds_read_u16_d16_hi v49, v107 offset:2052
    v_mul_u32_u24 v83, 2675, v15
    v_lshrrev_b32 v83, 18, v83
    v_mad_i32_i24 v106, v83, s10, v15
    v_lshlrev_b32 v83, 2, v83
    v_mul_u32_u24 v107, 171795, v8
    v_and_or_b32 v80, v107, s14, v8
    v_lshl_or_b32 v80, v106, 18, v80
    v_mul_u32_u24 v106, 6, v9
    ds_read_u16_d16_hi v50, v106 offset:2048
    ds_read_u16_d16_hi v51, v106 offset:2050
    ds_read_u16_d16_hi v52, v106 offset:2052
    v_mul_u32_u24 v107, 6, v16
    ds_read_u16_d16_hi v53, v107 offset:2048
    ds_read_u16_d16_hi v54, v107 offset:2050
    ds_read_u16_d16_hi v55, v107 offset:2052
    v_mul_u32_u24 v87, 2675, v16
    v_lshrrev_b32 v87, 18, v87
    v_mad_i32_i24 v106, v87, s10, v16
    v_lshlrev_b32 v87, 2, v87
    v_mul_u32_u24 v107, 171795, v9
    v_and_or_b32 v84, v107, s14, v9
    v_lshl_or_b32 v84, v106, 18, v84
    v_sub_f32 v32, v32, v35
    v_sub_f32 v33, v33, v36
    v_sub_f32 v34, v34, v37
    v_sub_f32 v38, v38, v41
    v_sub_f32 v39, v39, v42
    v_sub_f32 v40, v40, v43
    v_cvt_pk_bf16_f32 v108, v32, v33
    v_cvt_pk_bf16_f32 v109, v38, v39
    v_cvt_pk_bf16_f32 v110, v34, v40
    v_lshlrev_b32 v32, 16, v108
    v_and_b32 v33, s4, v108
    v_lshlrev_b32 v38, 16, v109
    v_and_b32 v39, s4, v109
    v_lshlrev_b32 v34, 16, v110
    v_and_b32 v40, s4, v110
    v_mul_f32 v35, v32, v32
    v_mul_f32 v36, v33, v33
    v_mul_f32 v37, v34, v34
    v_mul_f32 v41, v38, v38
    v_mul_f32 v42, v39, v39
    v_mul_f32 v43, v40, v40
    v_cvt_pk_bf16_f32 v108, v35, v36
    v_cvt_pk_bf16_f32 v109, v41, v42
    v_cvt_pk_bf16_f32 v110, v37, v43
    v_lshlrev_b32 v35, 16, v108
    v_and_b32 v36, s4, v108
    v_lshlrev_b32 v41, 16, v109
    v_and_b32 v42, s4, v109
    v_lshlrev_b32 v37, 16, v110
    v_and_b32 v43, s4, v110
    v_add_f32 v35, v35, v36
    v_add_f32 v41, v41, v42
    v_add_f32 v35, v35, v37
    v_add_f32 v41, v41, v43
    v_cvt_pk_bf16_f32 v110, v35, v41
    v_lshlrev_b32 v35, 16, v110
    v_and_b32 v41, s4, v110
    v_add_f32 v35, 0x322bcc77, v35
    v_add_f32 v41, 0x322bcc77, v41
    v_cvt_pk_bf16_f32 v110, v35, v41
    v_lshlrev_b32 v35, 16, v110
    v_and_b32 v41, s4, v110
    v_sqrt_f32 v35, v35
    v_sqrt_f32 v41, v41
    s_nop 0
    v_cvt_pk_bf16_f32 v110, v35, v41
    v_lshlrev_b32 v35, 16, v110
    v_and_b32 v41, s4, v110
    v_cmp_ge_u32 s[64:65], s9, v35
    v_cmp_ge_u32 s[66:67], s9, v41
    v_rcp_f32 v36, v35
    v_rcp_f32 v42, v41
    s_mov_b64 exec, s[64:65]
    ds_add_rtn_u32 v94, v75, v3 offset:0
    s_mov_b64 exec, s[66:67]
    ds_add_rtn_u32 v95, v79, v3 offset:0
    s_mov_b64 exec, -1
    v_mul_f32 v32, v32, v36
    v_mul_f32 v33, v33, v36
    v_mul_f32 v34, v34, v36
    v_cvt_pk_bf16_f32 v74, v33, v34
    v_cvt_pk_bf16_f32 v73, v35, v32
    v_xad_u32 v73, v73, s11, v100
    v_mul_f32 v38, v38, v42
    v_mul_f32 v39, v39, v42
    v_mul_f32 v40, v40, v42
    v_cvt_pk_bf16_f32 v78, v39, v40
    v_cvt_pk_bf16_f32 v77, v41, v38
    v_xad_u32 v77, v77, s11, v100
    s_waitcnt vmcnt(0) lgkmcnt(0)
    s_cmp_ge_u32 s3, 4
    s_cbranch_scc1 K1E_NO7A
    v_mul_u32_u24 v106, 6, v10
    ds_read_u16_d16_hi v56, v106 offset:2048
    ds_read_u16_d16_hi v57, v106 offset:2050
    ds_read_u16_d16_hi v58, v106 offset:2052
    v_mul_u32_u24 v107, 6, v17
    ds_read_u16_d16_hi v59, v107 offset:2048
    ds_read_u16_d16_hi v60, v107 offset:2050
    ds_read_u16_d16_hi v61, v107 offset:2052
    v_mul_u32_u24 v91, 2675, v17
    v_lshrrev_b32 v91, 18, v91
    v_mad_i32_i24 v106, v91, s10, v17
    v_lshlrev_b32 v91, 2, v91
    v_mul_u32_u24 v107, 171795, v10
    v_and_or_b32 v88, v107, s14, v10
    v_lshl_or_b32 v88, v106, 18, v88
K1E_NO7A:
    v_sub_f32 v44, v44, v47
    v_sub_f32 v45, v45, v48
    v_sub_f32 v46, v46, v49
    v_sub_f32 v50, v50, v53
    v_sub_f32 v51, v51, v54
    v_sub_f32 v52, v52, v55
    v_cvt_pk_bf16_f32 v108, v44, v45
    v_cvt_pk_bf16_f32 v109, v50, v51
    v_cvt_pk_bf16_f32 v110, v46, v52
    v_lshlrev_b32 v44, 16, v108
    v_and_b32 v45, s4, v108
    v_lshlrev_b32 v50, 16, v109
    v_and_b32 v51, s4, v109
    v_lshlrev_b32 v46, 16, v110
    v_and_b32 v52, s4, v110
    v_mul_f32 v47, v44, v44
    v_mul_f32 v48, v45, v45
    v_mul_f32 v49, v46, v46
    v_mul_f32 v53, v50, v50
    v_mul_f32 v54, v51, v51
    v_mul_f32 v55, v52, v52
    v_cvt_pk_bf16_f32 v108, v47, v48
    v_cvt_pk_bf16_f32 v109, v53, v54
    v_cvt_pk_bf16_f32 v110, v49, v55
    v_lshlrev_b32 v47, 16, v108
    v_and_b32 v48, s4, v108
    v_lshlrev_b32 v53, 16, v109
    v_and_b32 v54, s4, v109
    v_lshlrev_b32 v49, 16, v110
    v_and_b32 v55, s4, v110
    v_add_f32 v47, v47, v48
    v_add_f32 v53, v53, v54
    v_add_f32 v47, v47, v49
    v_add_f32 v53, v53, v55
    v_cvt_pk_bf16_f32 v110, v47, v53
    v_lshlrev_b32 v47, 16, v110
    v_and_b32 v53, s4, v110
    v_add_f32 v47, 0x322bcc77, v47
    v_add_f32 v53, 0x322bcc77, v53
    v_cvt_pk_bf16_f32 v110, v47, v53
    v_lshlrev_b32 v47, 16, v110
    v_and_b32 v53, s4, v110
    v_sqrt_f32 v47, v47
    v_sqrt_f32 v53, v53
    s_nop 0
    v_cvt_pk_bf16_f32 v110, v47, v53
    v_lshlrev_b32 v47, 16, v110
    v_and_b32 v53, s4, v110
    v_cmp_ge_u32 s[68:69], s9, v47
    v_cmp_ge_u32 s[70:71], s9, v53
    v_rcp_f32 v48, v47
    v_rcp_f32 v54, v53
    s_mov_b64 exec, s[68:69]
    ds_add_rtn_u32 v96, v83, v3 offset:0
    s_mov_b64 exec, s[70:71]
    ds_add_rtn_u32 v97, v87, v3 offset:0
    s_mov_b64 exec, -1
    v_mul_f32 v44, v44, v48
    v_mul_f32 v45, v45, v48
    v_mul_f32 v46, v46, v48
    v_cvt_pk_bf16_f32 v82, v45, v46
    v_cvt_pk_bf16_f32 v81, v47, v44
    v_xad_u32 v81, v81, s11, v100
    v_mul_f32 v50, v50, v54
    v_mul_f32 v51, v51, v54
    v_mul_f32 v52, v52, v54
    v_cvt_pk_bf16_f32 v86, v51, v52
    v_cvt_pk_bf16_f32 v85, v53, v50
    v_xad_u32 v85, v85, s11, v100
    s_mov_b64 s[72:73], 0
    s_waitcnt lgkmcnt(0)
    s_cmp_ge_u32 s3, 4
    s_cbranch_scc1 K1E_NO7B
    v_sub_f32 v56, v56, v59
    v_sub_f32 v57, v57, v60
    v_sub_f32 v58, v58, v61
    v_cvt_pk_bf16_f32 v108, v56, v57
    v_cvt_pk_bf16_f32 v110, v58, v58
    v_lshlrev_b32 v56, 16, v108
    v_and_b32 v57, s4, v108
    v_and_b32 v58, s4, v110
    v_mul_f32 v59, v56, v56
    v_mul_f32 v60, v57, v57
    v_mul_f32 v61, v58, v58
    v_cvt_pk_bf16_f32 v108, v59, v60
    v_cvt_pk_bf16_f32 v110, v61, v61
    v_lshlrev_b32 v59, 16, v108
    v_and_b32 v60, s4, v108
    v_and_b32 v61, s4, v110
    v_add_f32 v59, v59, v60
    v_add_f32 v59, v59, v61
    v_cvt_pk_bf16_f32 v110, v59, v59
    v_and_b32 v59, s4, v110
    v_add_f32 v59, 0x322bcc77, v59
    v_cvt_pk_bf16_f32 v110, v59, v59
    v_and_b32 v59, s4, v110
    v_sqrt_f32 v59, v59
    s_nop 0
    v_cvt_pk_bf16_f32 v110, v59, v59
    v_and_b32 v59, s4, v110
    v_cmp_ge_u32 s[72:73], s9, v59
    v_rcp_f32 v60, v59
    s_mov_b64 exec, s[72:73]
    ds_add_rtn_u32 v98, v91, v3 offset:0
    s_mov_b64 exec, -1
    v_mul_f32 v56, v56, v60
    v_mul_f32 v57, v57, v60
    v_mul_f32 v58, v58, v60
    v_cvt_pk_bf16_f32 v90, v57, v58
    v_cvt_pk_bf16_f32 v89, v59, v56
    v_xad_u32 v89, v89, s11, v100
    s_waitcnt lgkmcnt(0)
K1E_NO7B:
    s_barrier
    ds_read_b128 v[20:23], v2 offset:0
    s_waitcnt lgkmcnt(0)
    v_add_u32 v28, v20, v21
    v_add3_u32 v28, v28, v22, v23
    v_mov_b32 v29, v28
    s_nop 1
    v_add_u32_dpp v29, v29, v29 row_shr:1 row_mask:0xf bank_mask:0xf bound_ctrl:0
    s_nop 1
    v_add_u32_dpp v29, v29, v29 row_shr:2 row_mask:0xf bank_mask:0xf bound_ctrl:0
    s_nop 1
    v_add_u32_dpp v29, v29, v29 row_shr:4 row_mask:0xf bank_mask:0xf bound_ctrl:0
    s_nop 1
    v_add_u32_dpp v29, v29, v29 row_shr:8 row_mask:0xf bank_mask:0xf bound_ctrl:0
    s_nop 1
    v_add_u32_dpp v29, v29, v29 row_bcast:15 row_mask:0xa bank_mask:0xf
    s_nop 1
    v_add_u32_dpp v29, v29, v29 row_bcast:31 row_mask:0xc bank_mask:0xf
    v_sub_u32 v24, v29, v28
    v_add_u32 v25, v24, v20
    v_add_u32 v26, v25, v21
    v_add_u32 v27, v26, v22
    ds_write_b128 v2, v[24:27] offset:1024
    ds_read_b32 v40, v67 offset:1024
    ds_read_b32 v41, v71 offset:1024
    ds_read_b32 v42, v75 offset:1024
    ds_read_b32 v43, v79 offset:1024
    ds_read_b32 v44, v83 offset:1024
    ds_read_b32 v45, v87 offset:1024
    ds_read_b32 v46, v91 offset:1024
    v_readlane_b32 s13, v29, 63
    s_cmp_lg_u32 s3, 15
    s_cbranch_scc1 K1E_NOSEG
    v_lshl_or_b32 v32, v20, 16, v24
    v_lshl_or_b32 v33, v21, 16, v25
    v_lshl_or_b32 v34, v22, 16, v26
    v_lshl_or_b32 v35, v23, 16, v27
    s_lshl_b32 s5, s2, 10
    buffer_store_dwordx4 v[32:35], v2, s[52:55], s5 offen sc1
K1E_NOSEG:
    v_mov_b32 v36, 2048
    s_waitcnt lgkmcnt(0)
    v_add_u32 v40, v40, v92
    v_mad_u32_u24 v40, v40, 12, v36
    s_mov_b64 exec, s[60:61]
    ds_write2_b32 v40, v64, v65 offset0:0 offset1:1
    ds_write_b32 v40, v66 offset:8
    s_mov_b64 exec, -1
    v_add_u32 v41, v41, v93
    v_mad_u32_u24 v41, v41, 12, v36
    s_mov_b64 exec, s[62:63]
    ds_write2_b32 v41, v68, v69 offset0:0 offset1:1
    ds_write_b32 v41, v70 offset:8
    s_mov_b64 exec, -1
    v_add_u32 v42, v42, v94
    v_mad_u32_u24 v42, v42, 12, v36
    s_mov_b64 exec, s[64:65]
    ds_write2_b32 v42, v72, v73 offset0:0 offset1:1
    ds_write_b32 v42, v74 offset:8
    s_mov_b64 exec, -1
    v_add_u32 v43, v43, v95
    v_mad_u32_u24 v43, v43, 12, v36
    s_mov_b64 exec, s[66:67]
    ds_write2_b32 v43, v76, v77 offset0:0 offset1:1
    ds_write_b32 v43, v78 offset:8
    s_mov_b64 exec, -1
    v_add_u32 v44, v44, v96
    v_mad_u32_u24 v44, v44, 12, v36
    s_mov_b64 exec, s[68:69]
    ds_write2_b32 v44, v80, v81 offset0:0 offset1:1
    ds_write_b32 v44, v82 offset:8
    s_mov_b64 exec, -1
    v_add_u32 v45, v45, v97
    v_mad_u32_u24 v45, v45, 12, v36
    s_mov_b64 exec, s[70:71]
    ds_write2_b32 v45, v84, v85 offset0:0 offset1:1
    ds_write_b32 v45, v86 offset:8
    s_mov_b64 exec, -1
    v_add_u32 v46, v46, v98
    v_mad_u32_u24 v46, v46, 12, v36
    s_mov_b64 exec, s[72:73]
    ds_write2_b32 v46, v88, v89 offset0:0 offset1:1
    ds_write_b32 v46, v90 offset:8
    s_mov_b64 exec, -1
    s_mul_i32 s13, s13, 12
    s_mul_i32 s5, s2, 76800
    v_lshlrev_b32 v1, 4, v0
    v_add_u32 v4, 18432, v1
    s_waitcnt lgkmcnt(0)
    s_barrier
    ds_read_b128 v[20:23], v1 offset:2048
    ds_read_b128 v[24:27], v4 offset:0
    ds_read_b128 v[28:31], v4 offset:16384
    ds_read_b128 v[32:35], v4 offset:32768
    ds_read_b128 v[36:39], v4 offset:49152
    v_cmp_gt_u32 vcc, s13, v1
    s_and_b64 exec, exec, vcc
    s_cbranch_scc0 K1E_STDONE
    s_waitcnt lgkmcnt(4)
    buffer_store_dwordx4 v[20:23], v1, s[48:51], s5 offen sc1
    v_add_u32 v1, 16384, v1
    v_cmp_gt_u32 vcc, s13, v1
    s_and_b64 exec, exec, vcc
    s_cbranch_scc0 K1E_STDONE
    s_waitcnt lgkmcnt(3)
    buffer_store_dwordx4 v[24:27], v1, s[48:51], s5 offen sc1
    v_add_u32 v1, 16384, v1
    v_cmp_gt_u32 vcc, s13, v1
    s_and_b64 exec, exec, vcc
    s_cbranch_scc0 K1E_STDONE
    s_waitcnt lgkmcnt(2)
    buffer_store_dwordx4 v[28:31], v1, s[48:51], s5 offen sc1
    v_add_u32 v1, 16384, v1
    v_cmp_gt_u32 vcc, s13, v1
    s_and_b64 exec, exec, vcc
    s_cbranch_scc0 K1E_STDONE
    s_waitcnt lgkmcnt(1)
    buffer_store_dwordx4 v[32:35], v1, s[48:51], s5 offen sc1
    v_add_u32 v1, 16384, v1
    v_cmp_gt_u32 vcc, s13, v1
    s_and_b64 exec, exec, vcc
    s_cbranch_scc0 K1E_STDONE
    s_waitcnt lgkmcnt(0)
    buffer_store_dwordx4 v[36:39], v1, s[48:51], s5 offen sc1
    v_add_u32 v1, 16384, v1
K1E_STDONE:
    s_endpgm
K1_NODE:
    v_lshrrev_b32 v3, 4, v2
    v_and_b32 v4, 15, v2
    v_lshlrev_b32 v2, 4, v2
    s_cmp_lt_u32 s3, 2
    s_cselect_b32 s9, 1, 3
    s_cselect_b32 s11, 2, s3
    s_lshl_b32 s50, s9, 13
    s_mov_b32 s51, 0x20000
    s_lshl_b32 s9, s9, 7
    s_and_b32 s10, s3, 1
    s_mul_i32 s10, s10, s9
    s_lshl_b32 s10, s10, 5
    s_sub_u32 s11, s11, 2
    s_lshr_b32 s11, s11, 1
    s_lshl_b32 s11, s11, 7
    s_add_u32 s10, s10, s11
    s_lshl_b32 s11, s9, 3
    v_mul_u32_u24 v5, s11, v3
    v_lshl_add_u32 v5, v4, 2, v5
    s_sub_u32 s5, s2, 125
    s_mul_i32 s6, s5, 25
    s_add_u32 s7, s6, 25
    s_lshr_b32 s6, s6, 1
    s_lshr_b32 s7, s7, 1
    s_cmp_eq_u32 s5, 124
    s_addc_u32 s7, s7, 0
    s_add_u32 s6, s6, s3
    s_sub_u32 s6, s6, 3
    s_cmp_lt_u32 s3, 3
    s_cselect_b32 s6, s7, s6
    s_cmp_lt_u32 s6, s7
    s_cselect_b32 s6, s6, 0x4000
    s_lshl_b32 s12, s6, 13
    v_lshlrev_b32 v6, 9, v4
    v_lshl_add_u32 v6, v3, 4, v6
    v_lshlrev_b32 v7, 11, v3
    v_lshl_add_u32 v7, v4, 2, v7
    v_add_u32 v7, s12, v7
    s_cmp_lt_u32 s3, 2
    s_waitcnt lgkmcnt(0)
    s_cselect_b32 s48, s26, s28
    s_cselect_b32 s49, s27, s29
    s_mov_b32 s40, s16
    s_mov_b32 s41, s17
    s_mov_b32 s42, 12800000
    s_mov_b32 s43, 0x20000
    s_cmp_ge_u32 s3, 8
    s_cbranch_scc1 K1N_NOW
    v_add_u32 v5, s10, v5
    buffer_load_dword v104, v5, s[48:51], 0 offen
    buffer_load_dword v105, v5, s[48:51], 0 offen offset:64
    v_add_u32 v5, s9, v5
    buffer_load_dword v106, v5, s[48:51], 0 offen
    buffer_load_dword v107, v5, s[48:51], 0 offen offset:64
    v_add_u32 v5, s9, v5
    buffer_load_dword v108, v5, s[48:51], 0 offen
    buffer_load_dword v109, v5, s[48:51], 0 offen offset:64
    v_add_u32 v5, s9, v5
    buffer_load_dword v110, v5, s[48:51], 0 offen
    buffer_load_dword v111, v5, s[48:51], 0 offen offset:64
    v_add_u32 v5, s9, v5
    buffer_load_dword v112, v5, s[48:51], 0 offen
    buffer_load_dword v113, v5, s[48:51], 0 offen offset:64
    v_add_u32 v5, s9, v5
    buffer_load_dword v114, v5, s[48:51], 0 offen
    buffer_load_dword v115, v5, s[48:51], 0 offen offset:64
    v_add_u32 v5, s9, v5
    buffer_load_dword v116, v5, s[48:51], 0 offen
    buffer_load_dword v117, v5, s[48:51], 0 offen offset:64
    v_add_u32 v5, s9, v5
    buffer_load_dword v118, v5, s[48:51], 0 offen
    buffer_load_dword v119, v5, s[48:51], 0 offen offset:64
    v_add_u32 v5, s9, v5
K1N_NOW:
    buffer_load_dwordx4 v[40:43], v6, s[40:43], s12 offen
    buffer_load_dwordx4 v[44:47], v6, s[40:43], s12 offen offset:64
    s_mov_b32 s44, s32
    s_mov_b32 s45, s33
    s_mov_b32 s46, 12800000
    s_mov_b32 s47, 0x20000
    s_add_u32 s52, s32, 12800000
    s_addc_u32 s53, s33, 0
    s_mov_b32 s54, 3200000
    s_mov_b32 s55, 0x20000
    s_add_u32 s56, s32, 25858048
    s_addc_u32 s57, s33, 0
    s_mov_b32 s58, 1600
    s_mov_b32 s59, 0x20000
    s_cmp_lt_u32 s3, 8
    s_cbranch_scc1 K1N_STAGE
    buffer_load_dword v8, v7, s[40:43], 0 offen offset:128
    buffer_load_dword v9, v7, s[40:43], 0 offen offset:192
    buffer_load_dword v10, v7, s[40:43], 0 offen offset:256
    buffer_load_dword v11, v7, s[40:43], 0 offen offset:320
    buffer_load_dword v12, v7, s[40:43], 0 offen offset:384
    buffer_load_dword v13, v7, s[40:43], 0 offen offset:448
    buffer_load_dword v14, v7, s[40:43], 0 offen offset:640
    buffer_load_dword v15, v7, s[40:43], 0 offen offset:704
    buffer_load_dword v16, v7, s[40:43], 0 offen offset:768
    buffer_load_dword v17, v7, s[40:43], 0 offen offset:832
    buffer_load_dword v18, v7, s[40:43], 0 offen offset:896
    buffer_load_dword v19, v7, s[40:43], 0 offen offset:960
    buffer_load_dword v20, v7, s[40:43], 0 offen offset:1152
    buffer_load_dword v21, v7, s[40:43], 0 offen offset:1216
    buffer_load_dword v22, v7, s[40:43], 0 offen offset:1280
    buffer_load_dword v23, v7, s[40:43], 0 offen offset:1344
    buffer_load_dword v24, v7, s[40:43], 0 offen offset:1408
    buffer_load_dword v25, v7, s[40:43], 0 offen offset:1472
    buffer_load_dword v26, v7, s[40:43], 0 offen offset:1664
    buffer_load_dword v27, v7, s[40:43], 0 offen offset:1728
    buffer_load_dword v28, v7, s[40:43], 0 offen offset:1792
    buffer_load_dword v29, v7, s[40:43], 0 offen offset:1856
    buffer_load_dword v30, v7, s[40:43], 0 offen offset:1920
    buffer_load_dword v31, v7, s[40:43], 0 offen offset:1984
    s_barrier
    s_branch K1N_GO
K1N_STAGE:
    s_mov_b32 s14, 0x05040100
    s_mov_b32 s15, 0x07060302
    s_lshl_b32 s10, s3, 12
    v_add_u32 v5, s10, v2
    s_waitcnt vmcnt(2)
    v_perm_b32 v88, v106, v104, s14
    v_perm_b32 v89, v110, v108, s14
    v_perm_b32 v90, v114, v112, s14
    v_perm_b32 v91, v118, v116, s14
    ds_write_b128 v5, v[88:91] offset:0
    v_perm_b32 v92, v106, v104, s15
    v_perm_b32 v93, v110, v108, s15
    v_perm_b32 v94, v114, v112, s15
    v_perm_b32 v95, v118, v116, s15
    ds_write_b128 v5, v[92:95] offset:1024
    v_perm_b32 v96, v107, v105, s14
    v_perm_b32 v97, v111, v109, s14
    v_perm_b32 v98, v115, v113, s14
    v_perm_b32 v99, v119, v117, s14
    ds_write_b128 v5, v[96:99] offset:2048
    v_perm_b32 v100, v107, v105, s15
    v_perm_b32 v101, v111, v109, s15
    v_perm_b32 v102, v115, v113, s15
    v_perm_b32 v103, v119, v117, s15
    ds_write_b128 v5, v[100:103] offset:3072
    s_waitcnt lgkmcnt(0)
    s_barrier
    s_cmp_lt_u32 s3, 3
    s_cbranch_scc1 K1_END
    buffer_load_dword v8, v7, s[40:43], 0 offen offset:128
    buffer_load_dword v9, v7, s[40:43], 0 offen offset:192
    buffer_load_dword v10, v7, s[40:43], 0 offen offset:256
    buffer_load_dword v11, v7, s[40:43], 0 offen offset:320
    buffer_load_dword v12, v7, s[40:43], 0 offen offset:384
    buffer_load_dword v13, v7, s[40:43], 0 offen offset:448
    buffer_load_dword v14, v7, s[40:43], 0 offen offset:640
    buffer_load_dword v15, v7, s[40:43], 0 offen offset:704
    buffer_load_dword v16, v7, s[40:43], 0 offen offset:768
    buffer_load_dword v17, v7, s[40:43], 0 offen offset:832
    buffer_load_dword v18, v7, s[40:43], 0 offen offset:896
    buffer_load_dword v19, v7, s[40:43], 0 offen offset:960
    buffer_load_dword v20, v7, s[40:43], 0 offen offset:1152
    buffer_load_dword v21, v7, s[40:43], 0 offen offset:1216
    buffer_load_dword v22, v7, s[40:43], 0 offen offset:1280
    buffer_load_dword v23, v7, s[40:43], 0 offen offset:1344
    buffer_load_dword v24, v7, s[40:43], 0 offen offset:1408
    buffer_load_dword v25, v7, s[40:43], 0 offen offset:1472
    buffer_load_dword v26, v7, s[40:43], 0 offen offset:1664
    buffer_load_dword v27, v7, s[40:43], 0 offen offset:1728
    buffer_load_dword v28, v7, s[40:43], 0 offen offset:1792
    buffer_load_dword v29, v7, s[40:43], 0 offen offset:1856
    buffer_load_dword v30, v7, s[40:43], 0 offen offset:1920
    buffer_load_dword v31, v7, s[40:43], 0 offen offset:1984
K1N_GO:
    s_cmp_ge_u32 s6, s7
    s_cbranch_scc1 K1_END
    ds_read_b128 v[48:51], v2 offset:0
    ds_read_b128 v[52:55], v2 offset:1024
    ds_read_b128 v[56:59], v2 offset:2048
    ds_read_b128 v[60:63], v2 offset:3072
    ds_read_b128 v[64:67], v2 offset:4096
    ds_read_b128 v[68:71], v2 offset:5120
    ds_read_b128 v[72:75], v2 offset:6144
    ds_read_b128 v[76:79], v2 offset:7168
    s_waitcnt vmcnt(24)
    s_waitcnt lgkmcnt(7)
    v_mfma_f32_16x16x32_bf16 v[104:107], v[48:51], v[40:43], 0
    s_waitcnt lgkmcnt(6)
    v_mfma_f32_16x16x32_bf16 v[108:111], v[52:55], v[40:43], 0
    s_waitcnt lgkmcnt(5)
    v_mfma_f32_16x16x32_bf16 v[112:115], v[56:59], v[40:43], 0
    s_waitcnt lgkmcnt(4)
    v_mfma_f32_16x16x32_bf16 v[116:119], v[60:63], v[40:43], 0
    s_waitcnt lgkmcnt(3)
    v_mfma_f32_16x16x32_bf16 v[104:107], v[64:67], v[44:47], v[104:107]
    s_waitcnt lgkmcnt(2)
    v_mfma_f32_16x16x32_bf16 v[108:111], v[68:71], v[44:47], v[108:111]
    s_waitcnt lgkmcnt(1)
    v_mfma_f32_16x16x32_bf16 v[112:115], v[72:75], v[44:47], v[112:115]
    s_waitcnt lgkmcnt(0)
    v_mfma_f32_16x16x32_bf16 v[116:119], v[76:79], v[44:47], v[116:119]
    ds_read_b128 v[48:51], v2 offset:8192
    ds_read_b128 v[52:55], v2 offset:9216
    ds_read_b128 v[56:59], v2 offset:10240
    ds_read_b128 v[60:63], v2 offset:11264
    ds_read_b128 v[64:67], v2 offset:12288
    ds_read_b128 v[68:71], v2 offset:13312
    ds_read_b128 v[72:75], v2 offset:14336
    ds_read_b128 v[76:79], v2 offset:15360
    v_cvt_pk_bf16_f32 v80, v104, v105
    v_cvt_pk_bf16_f32 v81, v106, v107
    v_cvt_pk_bf16_f32 v82, v108, v109
    v_cvt_pk_bf16_f32 v83, v110, v111
    v_cvt_pk_bf16_f32 v84, v112, v113
    v_cvt_pk_bf16_f32 v85, v114, v115
    v_cvt_pk_bf16_f32 v86, v116, v117
    v_cvt_pk_bf16_f32 v87, v118, v119
    v_lshlrev_b32 v104, 16, v80
    v_and_b32 v105, s4, v80
    v_lshlrev_b32 v106, 16, v81
    v_and_b32 v107, s4, v81
    v_lshlrev_b32 v108, 16, v82
    v_and_b32 v109, s4, v82
    v_lshlrev_b32 v110, 16, v83
    v_and_b32 v111, s4, v83
    v_lshlrev_b32 v112, 16, v84
    v_and_b32 v113, s4, v84
    v_lshlrev_b32 v114, 16, v85
    v_and_b32 v115, s4, v85
    v_lshlrev_b32 v116, 16, v86
    v_and_b32 v117, s4, v86
    v_lshlrev_b32 v118, 16, v87
    v_and_b32 v119, s4, v87
    v_mul_f32 v88, 0xbfb8aa3b, v104
    v_mul_f32 v89, 0xbfb8aa3b, v105
    v_mul_f32 v90, 0xbfb8aa3b, v106
    v_mul_f32 v91, 0xbfb8aa3b, v107
    v_mul_f32 v92, 0xbfb8aa3b, v108
    v_mul_f32 v93, 0xbfb8aa3b, v109
    v_mul_f32 v94, 0xbfb8aa3b, v110
    v_mul_f32 v95, 0xbfb8aa3b, v111
    v_mul_f32 v96, 0xbfb8aa3b, v112
    v_mul_f32 v97, 0xbfb8aa3b, v113
    v_mul_f32 v98, 0xbfb8aa3b, v114
    v_mul_f32 v99, 0xbfb8aa3b, v115
    v_mul_f32 v100, 0xbfb8aa3b, v116
    v_mul_f32 v101, 0xbfb8aa3b, v117
    v_mul_f32 v102, 0xbfb8aa3b, v118
    v_mul_f32 v103, 0xbfb8aa3b, v119
    v_exp_f32 v88, v88
    v_exp_f32 v89, v89
    v_exp_f32 v90, v90
    v_exp_f32 v91, v91
    v_exp_f32 v92, v92
    v_exp_f32 v93, v93
    v_exp_f32 v94, v94
    v_exp_f32 v95, v95
    v_exp_f32 v96, v96
    v_exp_f32 v97, v97
    v_exp_f32 v98, v98
    v_exp_f32 v99, v99
    v_exp_f32 v100, v100
    v_exp_f32 v101, v101
    v_exp_f32 v102, v102
    v_exp_f32 v103, v103
    v_add_f32 v88, 1.0, v88
    v_add_f32 v89, 1.0, v89
    v_add_f32 v90, 1.0, v90
    v_add_f32 v91, 1.0, v91
    v_add_f32 v92, 1.0, v92
    v_add_f32 v93, 1.0, v93
    v_add_f32 v94, 1.0, v94
    v_add_f32 v95, 1.0, v95
    v_add_f32 v96, 1.0, v96
    v_add_f32 v97, 1.0, v97
    v_add_f32 v98, 1.0, v98
    v_add_f32 v99, 1.0, v99
    v_add_f32 v100, 1.0, v100
    v_add_f32 v101, 1.0, v101
    v_add_f32 v102, 1.0, v102
    v_add_f32 v103, 1.0, v103
    v_rcp_f32 v88, v88
    v_rcp_f32 v89, v89
    v_rcp_f32 v90, v90
    v_rcp_f32 v91, v91
    v_rcp_f32 v92, v92
    v_rcp_f32 v93, v93
    v_rcp_f32 v94, v94
    v_rcp_f32 v95, v95
    v_rcp_f32 v96, v96
    v_rcp_f32 v97, v97
    v_rcp_f32 v98, v98
    v_rcp_f32 v99, v99
    v_rcp_f32 v100, v100
    v_rcp_f32 v101, v101
    v_rcp_f32 v102, v102
    v_rcp_f32 v103, v103
    v_mul_f32 v104, v104, v88
    v_mul_f32 v105, v105, v89
    v_mul_f32 v106, v106, v90
    v_mul_f32 v107, v107, v91
    v_mul_f32 v108, v108, v92
    v_mul_f32 v109, v109, v93
    v_mul_f32 v110, v110, v94
    v_mul_f32 v111, v111, v95
    v_mul_f32 v112, v112, v96
    v_mul_f32 v113, v113, v97
    v_mul_f32 v114, v114, v98
    v_mul_f32 v115, v115, v99
    v_mul_f32 v116, v116, v100
    v_mul_f32 v117, v117, v101
    v_mul_f32 v118, v118, v102
    v_mul_f32 v119, v119, v103
    v_cvt_pk_bf16_f32 v120, v104, v108
    v_cvt_pk_bf16_f32 v121, v105, v109
    v_cvt_pk_bf16_f32 v122, v106, v110
    v_cvt_pk_bf16_f32 v123, v107, v111
    v_cvt_pk_bf16_f32 v124, v112, v116
    v_cvt_pk_bf16_f32 v125, v113, v117
    v_cvt_pk_bf16_f32 v126, v114, v118
    v_cvt_pk_bf16_f32 v127, v115, v119
    s_waitcnt lgkmcnt(7)
    v_mfma_f32_16x16x32_bf16 v[80:83], v[120:123], v[48:51], 0
    s_waitcnt lgkmcnt(6)
    v_mfma_f32_16x16x32_bf16 v[84:87], v[120:123], v[52:55], 0
    s_waitcnt lgkmcnt(5)
    v_mfma_f32_16x16x32_bf16 v[88:91], v[120:123], v[56:59], 0
    s_waitcnt lgkmcnt(4)
    v_mfma_f32_16x16x32_bf16 v[92:95], v[120:123], v[60:63], 0
    s_waitcnt lgkmcnt(3)
    v_mfma_f32_16x16x32_bf16 v[80:83], v[124:127], v[64:67], v[80:83]
    s_waitcnt lgkmcnt(2)
    v_mfma_f32_16x16x32_bf16 v[84:87], v[124:127], v[68:71], v[84:87]
    s_waitcnt lgkmcnt(1)
    v_mfma_f32_16x16x32_bf16 v[88:91], v[124:127], v[72:75], v[88:91]
    s_waitcnt lgkmcnt(0)
    v_mfma_f32_16x16x32_bf16 v[92:95], v[124:127], v[76:79], v[92:95]
    ds_read_b128 v[48:51], v2 offset:16384
    ds_read_b128 v[52:55], v2 offset:17408
    ds_read_b128 v[56:59], v2 offset:18432
    ds_read_b128 v[60:63], v2 offset:19456
    ds_read_b128 v[64:67], v2 offset:20480
    ds_read_b128 v[68:71], v2 offset:21504
    ds_read_b128 v[72:75], v2 offset:22528
    ds_read_b128 v[76:79], v2 offset:23552
    s_waitcnt lgkmcnt(7)
    v_mfma_f32_16x16x32_bf16 v[96:99], v[120:123], v[48:51], 0
    s_waitcnt lgkmcnt(6)
    v_mfma_f32_16x16x32_bf16 v[100:103], v[120:123], v[52:55], 0
    s_waitcnt lgkmcnt(5)
    v_mfma_f32_16x16x32_bf16 v[104:107], v[120:123], v[56:59], 0
    s_waitcnt lgkmcnt(4)
    v_mfma_f32_16x16x32_bf16 v[108:111], v[120:123], v[60:63], 0
    s_waitcnt lgkmcnt(3)
    v_mfma_f32_16x16x32_bf16 v[96:99], v[124:127], v[64:67], v[96:99]
    s_waitcnt lgkmcnt(2)
    v_mfma_f32_16x16x32_bf16 v[100:103], v[124:127], v[68:71], v[100:103]
    s_waitcnt lgkmcnt(1)
    v_mfma_f32_16x16x32_bf16 v[104:107], v[124:127], v[72:75], v[104:107]
    s_waitcnt lgkmcnt(0)
    v_mfma_f32_16x16x32_bf16 v[108:111], v[124:127], v[76:79], v[108:111]
    ds_read_b128 v[48:51], v2 offset:24576
    ds_read_b128 v[52:55], v2 offset:25600
    ds_read_b128 v[56:59], v2 offset:26624
    ds_read_b128 v[60:63], v2 offset:27648
    ds_read_b128 v[64:67], v2 offset:28672
    ds_read_b128 v[68:71], v2 offset:29696
    ds_read_b128 v[72:75], v2 offset:30720
    ds_read_b128 v[76:79], v2 offset:31744
    s_waitcnt lgkmcnt(7)
    v_mfma_f32_16x16x32_bf16 v[32:35], v[120:123], v[48:51], 0
    s_waitcnt lgkmcnt(6)
    v_mfma_f32_16x16x32_bf16 v[36:39], v[120:123], v[52:55], 0
    s_waitcnt lgkmcnt(5)
    v_mfma_f32_16x16x32_bf16 v[40:43], v[120:123], v[56:59], 0
    s_waitcnt lgkmcnt(4)
    v_mfma_f32_16x16x32_bf16 v[44:47], v[120:123], v[60:63], 0
    s_waitcnt lgkmcnt(3)
    v_mfma_f32_16x16x32_bf16 v[32:35], v[124:127], v[64:67], v[32:35]
    s_waitcnt lgkmcnt(2)
    v_mfma_f32_16x16x32_bf16 v[36:39], v[124:127], v[68:71], v[36:39]
    s_waitcnt lgkmcnt(1)
    v_mfma_f32_16x16x32_bf16 v[40:43], v[124:127], v[72:75], v[40:43]
    s_waitcnt lgkmcnt(0)
    v_mfma_f32_16x16x32_bf16 v[44:47], v[124:127], v[76:79], v[44:47]
    s_waitcnt vmcnt(0)
    v_add_u32 v112, v8, v8
    v_add_u32 v113, v9, v9
    v_add_u32 v114, v10, v10
    v_pk_max_u16 v112, v112, v114
    v_add_u32 v115, v11, v11
    v_pk_max_u16 v113, v113, v115
    v_add_u32 v114, v12, v12
    v_pk_max_u16 v112, v112, v114
    v_add_u32 v115, v13, v13
    v_pk_max_u16 v113, v113, v115
    v_add_u32 v114, v14, v14
    v_pk_max_u16 v112, v112, v114
    v_add_u32 v115, v15, v15
    v_pk_max_u16 v113, v113, v115
    v_add_u32 v114, v16, v16
    v_pk_max_u16 v112, v112, v114
    v_add_u32 v115, v17, v17
    v_pk_max_u16 v113, v113, v115
    v_add_u32 v114, v18, v18
    v_pk_max_u16 v112, v112, v114
    v_add_u32 v115, v19, v19
    v_pk_max_u16 v113, v113, v115
    v_add_u32 v114, v20, v20
    v_pk_max_u16 v112, v112, v114
    v_add_u32 v115, v21, v21
    v_pk_max_u16 v113, v113, v115
    v_add_u32 v114, v22, v22
    v_pk_max_u16 v112, v112, v114
    v_add_u32 v115, v23, v23
    v_pk_max_u16 v113, v113, v115
    v_add_u32 v114, v24, v24
    v_pk_max_u16 v112, v112, v114
    v_add_u32 v115, v25, v25
    v_pk_max_u16 v113, v113, v115
    v_add_u32 v114, v26, v26
    v_pk_max_u16 v112, v112, v114
    v_add_u32 v115, v27, v27
    v_pk_max_u16 v113, v113, v115
    v_add_u32 v114, v28, v28
    v_pk_max_u16 v112, v112, v114
    v_add_u32 v115, v29, v29
    v_pk_max_u16 v113, v113, v115
    v_add_u32 v114, v30, v30
    v_pk_max_u16 v112, v112, v114
    v_add_u32 v115, v31, v31
    v_pk_max_u16 v113, v113, v115
    v_mov_b32 v5, 0
    v_mov_b32 v6, 0
    v_max3_f32 v5, abs(v80), abs(v81), v5
    v_max3_f32 v6, abs(v82), abs(v83), v6
    v_max3_f32 v5, abs(v84), abs(v85), v5
    v_max3_f32 v6, abs(v86), abs(v87), v6
    v_max3_f32 v5, abs(v88), abs(v89), v5
    v_max3_f32 v6, abs(v90), abs(v91), v6
    v_max3_f32 v5, abs(v92), abs(v93), v5
    v_max3_f32 v6, abs(v94), abs(v95), v6
    v_max3_f32 v5, abs(v96), abs(v97), v5
    v_max3_f32 v6, abs(v98), abs(v99), v6
    v_max3_f32 v5, abs(v100), abs(v101), v5
    v_max3_f32 v6, abs(v102), abs(v103), v6
    v_max3_f32 v5, abs(v104), abs(v105), v5
    v_max3_f32 v6, abs(v106), abs(v107), v6
    v_max3_f32 v5, abs(v108), abs(v109), v5
    v_max3_f32 v6, abs(v110), abs(v111), v6
    v_max3_f32 v5, abs(v32), abs(v33), v5
    v_max3_f32 v6, abs(v34), abs(v35), v6
    v_max3_f32 v5, abs(v36), abs(v37), v5
    v_max3_f32 v6, abs(v38), abs(v39), v6
    v_max3_f32 v5, abs(v40), abs(v41), v5
    v_max3_f32 v6, abs(v42), abs(v43), v6
    v_max3_f32 v5, abs(v44), abs(v45), v5
    v_max3_f32 v6, abs(v46), abs(v47), v6
    v_pk_max_u16 v112, v112, v113
    v_max_f32 v5, v5, v6
    v_lshlrev_b32 v113, 16, v112
    v_max_u32 v112, v112, v113
    v_lshrrev_b32 v112, 24, v112
    v_lshrrev_b32 v5, 23, v5
    v_lshl_or_b32 v5, v112, 16, v5
    s_nop 1
    v_mov_b32_dpp v6, v5 row_ror:8 row_mask:0xf bank_mask:0xf
    v_pk_max_u16 v5, v5, v6
    s_nop 1
    v_mov_b32_dpp v6, v5 row_ror:4 row_mask:0xf bank_mask:0xf
    v_pk_max_u16 v5, v5, v6
    s_nop 1
    v_mov_b32_dpp v6, v5 row_ror:2 row_mask:0xf bank_mask:0xf
    v_pk_max_u16 v5, v5, v6
    s_nop 1
    v_mov_b32_dpp v6, v5 row_ror:1 row_mask:0xf bank_mask:0xf
    v_pk_max_u16 v5, v5, v6
    v_mov_b32 v6, v5
    s_nop 1
    v_permlane32_swap_b32 v5, v6
    v_pk_max_u16 v5, v5, v6
    s_nop 0
    v_readlane_b32 s60, v5, 0
    v_readlane_b32 s61, v5, 16
    s_nop 1
    s_and_b32 s64, s60, 0xffff
    s_and_b32 s65, s61, 0xffff
    s_max_u32 s64, s64, s65
    s_max_u32 s60, s60, s61
    s_lshr_b32 s60, s60, 16
    s_max_u32 s60, s60, 126
    s_sub_u32 s60, s60, 126
    s_add_u32 s64, s64, s60
    s_max_u32 s64, s64, 13
    s_min_u32 s64, s64, 254
    s_sub_u32 s9, 267, s64
    s_lshl_b32 s9, s9, 23
    s_lshl_b32 s11, s6, 11
    v_lshlrev_b32 v6, 11, v3
    v_lshl_add_u32 v6, v4, 4, v6
    v_lshrrev_b32 v7, 2, v6
    v_add_u32 v7, s11, v7
    v_mov_b32 v5, s64
    s_mov_b64 exec, 1
    buffer_store_byte v5, v2, s[56:59], s6 offen
    s_mov_b64 exec, -1
    v_mul_f32 v80, s9, v80
    v_mul_f32 v81, s9, v81
    v_mul_f32 v82, s9, v82
    v_mul_f32 v83, s9, v83
    v_mul_f32 v84, s9, v84
    v_mul_f32 v85, s9, v85
    v_mul_f32 v86, s9, v86
    v_mul_f32 v87, s9, v87
    v_mul_f32 v88, s9, v88
    v_mul_f32 v89, s9, v89
    v_mul_f32 v90, s9, v90
    v_mul_f32 v91, s9, v91
    v_mul_f32 v92, s9, v92
    v_mul_f32 v93, s9, v93
    v_mul_f32 v94, s9, v94
    v_mul_f32 v95, s9, v95
    v_mul_f32 v96, s9, v96
    v_mul_f32 v97, s9, v97
    v_mul_f32 v98, s9, v98
    v_mul_f32 v99, s9, v99
    v_mul_f32 v100, s9, v100
    v_mul_f32 v101, s9, v101
    v_mul_f32 v102, s9, v102
    v_mul_f32 v103, s9, v103
    v_mul_f32 v104, s9, v104
    v_mul_f32 v105, s9, v105
    v_mul_f32 v106, s9, v106
    v_mul_f32 v107, s9, v107
    v_mul_f32 v108, s9, v108
    v_mul_f32 v109, s9, v109
    v_mul_f32 v110, s9, v110
    v_mul_f32 v111, s9, v111
    v_mul_f32 v32, s9, v32
    v_mul_f32 v33, s9, v33
    v_mul_f32 v34, s9, v34
    v_mul_f32 v35, s9, v35
    v_mul_f32 v36, s9, v36
    v_mul_f32 v37, s9, v37
    v_mul_f32 v38, s9, v38
    v_mul_f32 v39, s9, v39
    v_mul_f32 v40, s9, v40
    v_mul_f32 v41, s9, v41
    v_mul_f32 v42, s9, v42
    v_mul_f32 v43, s9, v43
    v_mul_f32 v44, s9, v44
    v_mul_f32 v45, s9, v45
    v_mul_f32 v46, s9, v46
    v_mul_f32 v47, s9, v47
    v_cvt_pk_f16_f32 v48, v80, v84
    v_lshlrev_b32 v112, 16, v8
    v_and_b32 v113, s4, v8
    v_mul_f32 v112, v112, v96
    v_mul_f32 v113, v113, v100
    v_cvt_pk_f16_f32 v49, v112, v113
    v_lshlrev_b32 v114, 16, v10
    v_and_b32 v115, s4, v10
    v_mul_f32 v114, v114, v96
    v_mul_f32 v115, v115, v100
    v_cvt_pk_f16_f32 v50, v114, v115
    v_lshlrev_b32 v116, 16, v12
    v_and_b32 v117, s4, v12
    v_mul_f32 v116, v116, v96
    v_mul_f32 v117, v117, v100
    v_cvt_pk_f16_f32 v51, v116, v117
    buffer_store_dwordx4 v[48:51], v6, s[44:47], s12 offen offset:0 sc1
    v_cvt_pk_f16_f32 v120, v32, v36
    buffer_store_dword v120, v7, s[52:55], 0 offen offset:0 sc1
    v_cvt_pk_f16_f32 v52, v88, v92
    v_lshlrev_b32 v112, 16, v9
    v_and_b32 v113, s4, v9
    v_mul_f32 v112, v112, v104
    v_mul_f32 v113, v113, v108
    v_cvt_pk_f16_f32 v53, v112, v113
    v_lshlrev_b32 v114, 16, v11
    v_and_b32 v115, s4, v11
    v_mul_f32 v114, v114, v104
    v_mul_f32 v115, v115, v108
    v_cvt_pk_f16_f32 v54, v114, v115
    v_lshlrev_b32 v116, 16, v13
    v_and_b32 v117, s4, v13
    v_mul_f32 v116, v116, v104
    v_mul_f32 v117, v117, v108
    v_cvt_pk_f16_f32 v55, v116, v117
    buffer_store_dwordx4 v[52:55], v6, s[44:47], s12 offen offset:256 sc1
    v_cvt_pk_f16_f32 v121, v40, v44
    buffer_store_dword v121, v7, s[52:55], 0 offen offset:64 sc1
    v_cvt_pk_f16_f32 v56, v81, v85
    v_lshlrev_b32 v112, 16, v14
    v_and_b32 v113, s4, v14
    v_mul_f32 v112, v112, v97
    v_mul_f32 v113, v113, v101
    v_cvt_pk_f16_f32 v57, v112, v113
    v_lshlrev_b32 v114, 16, v16
    v_and_b32 v115, s4, v16
    v_mul_f32 v114, v114, v97
    v_mul_f32 v115, v115, v101
    v_cvt_pk_f16_f32 v58, v114, v115
    v_lshlrev_b32 v116, 16, v18
    v_and_b32 v117, s4, v18
    v_mul_f32 v116, v116, v97
    v_mul_f32 v117, v117, v101
    v_cvt_pk_f16_f32 v59, v116, v117
    buffer_store_dwordx4 v[56:59], v6, s[44:47], s12 offen offset:512 sc1
    v_cvt_pk_f16_f32 v122, v33, v37
    buffer_store_dword v122, v7, s[52:55], 0 offen offset:128 sc1
    v_cvt_pk_f16_f32 v60, v89, v93
    v_lshlrev_b32 v112, 16, v15
    v_and_b32 v113, s4, v15
    v_mul_f32 v112, v112, v105
    v_mul_f32 v113, v113, v109
    v_cvt_pk_f16_f32 v61, v112, v113
    v_lshlrev_b32 v114, 16, v17
    v_and_b32 v115, s4, v17
    v_mul_f32 v114, v114, v105
    v_mul_f32 v115, v115, v109
    v_cvt_pk_f16_f32 v62, v114, v115
    v_lshlrev_b32 v116, 16, v19
    v_and_b32 v117, s4, v19
    v_mul_f32 v116, v116, v105
    v_mul_f32 v117, v117, v109
    v_cvt_pk_f16_f32 v63, v116, v117
    buffer_store_dwordx4 v[60:63], v6, s[44:47], s12 offen offset:768 sc1
    v_cvt_pk_f16_f32 v123, v41, v45
    buffer_store_dword v123, v7, s[52:55], 0 offen offset:192 sc1
    v_cvt_pk_f16_f32 v64, v82, v86
    v_lshlrev_b32 v112, 16, v20
    v_and_b32 v113, s4, v20
    v_mul_f32 v112, v112, v98
    v_mul_f32 v113, v113, v102
    v_cvt_pk_f16_f32 v65, v112, v113
    v_lshlrev_b32 v114, 16, v22
    v_and_b32 v115, s4, v22
    v_mul_f32 v114, v114, v98
    v_mul_f32 v115, v115, v102
    v_cvt_pk_f16_f32 v66, v114, v115
    v_lshlrev_b32 v116, 16, v24
    v_and_b32 v117, s4, v24
    v_mul_f32 v116, v116, v98
    v_mul_f32 v117, v117, v102
    v_cvt_pk_f16_f32 v67, v116, v117
    buffer_store_dwordx4 v[64:67], v6, s[44:47], s12 offen offset:1024 sc1
    v_cvt_pk_f16_f32 v124, v34, v38
    buffer_store_dword v124, v7, s[52:55], 0 offen offset:256 sc1
    v_cvt_pk_f16_f32 v68, v90, v94
    v_lshlrev_b32 v112, 16, v21
    v_and_b32 v113, s4, v21
    v_mul_f32 v112, v112, v106
    v_mul_f32 v113, v113, v110
    v_cvt_pk_f16_f32 v69, v112, v113
    v_lshlrev_b32 v114, 16, v23
    v_and_b32 v115, s4, v23
    v_mul_f32 v114, v114, v106
    v_mul_f32 v115, v115, v110
    v_cvt_pk_f16_f32 v70, v114, v115
    v_lshlrev_b32 v116, 16, v25
    v_and_b32 v117, s4, v25
    v_mul_f32 v116, v116, v106
    v_mul_f32 v117, v117, v110
    v_cvt_pk_f16_f32 v71, v116, v117
    buffer_store_dwordx4 v[68:71], v6, s[44:47], s12 offen offset:1280 sc1
    v_cvt_pk_f16_f32 v125, v42, v46
    buffer_store_dword v125, v7, s[52:55], 0 offen offset:320 sc1
    v_cvt_pk_f16_f32 v72, v83, v87
    v_lshlrev_b32 v112, 16, v26
    v_and_b32 v113, s4, v26
    v_mul_f32 v112, v112, v99
    v_mul_f32 v113, v113, v103
    v_cvt_pk_f16_f32 v73, v112, v113
    v_lshlrev_b32 v114, 16, v28
    v_and_b32 v115, s4, v28
    v_mul_f32 v114, v114, v99
    v_mul_f32 v115, v115, v103
    v_cvt_pk_f16_f32 v74, v114, v115
    v_lshlrev_b32 v116, 16, v30
    v_and_b32 v117, s4, v30
    v_mul_f32 v116, v116, v99
    v_mul_f32 v117, v117, v103
    v_cvt_pk_f16_f32 v75, v116, v117
    buffer_store_dwordx4 v[72:75], v6, s[44:47], s12 offen offset:1536 sc1
    v_cvt_pk_f16_f32 v126, v35, v39
    buffer_store_dword v126, v7, s[52:55], 0 offen offset:384 sc1
    v_cvt_pk_f16_f32 v76, v91, v95
    v_lshlrev_b32 v112, 16, v27
    v_and_b32 v113, s4, v27
    v_mul_f32 v112, v112, v107
    v_mul_f32 v113, v113, v111
    v_cvt_pk_f16_f32 v77, v112, v113
    v_lshlrev_b32 v114, 16, v29
    v_and_b32 v115, s4, v29
    v_mul_f32 v114, v114, v107
    v_mul_f32 v115, v115, v111
    v_cvt_pk_f16_f32 v78, v114, v115
    v_lshlrev_b32 v116, 16, v31
    v_and_b32 v117, s4, v31
    v_mul_f32 v116, v116, v107
    v_mul_f32 v117, v117, v111
    v_cvt_pk_f16_f32 v79, v116, v117
    buffer_store_dwordx4 v[76:79], v6, s[44:47], s12 offen offset:1792 sc1
    v_cvt_pk_f16_f32 v127, v43, v47
    buffer_store_dword v127, v7, s[52:55], 0 offen offset:448 sc1
    s_endpgm
K1_GTAB:
    v_lshrrev_b32 v3, 4, v2
    v_and_b32 v4, 15, v2
    s_sub_u32 s5, s2, 250
    s_waitcnt lgkmcnt(0)
    s_mov_b32 s36, s30
    s_mov_b32 s37, s31
    s_mov_b32 s38, 6144
    s_mov_b32 s39, 0x20000
    s_mov_b32 s40, s24
    s_mov_b32 s41, s25
    s_mov_b32 s42, 32
    s_mov_b32 s43, 0x20000
    s_add_u32 s44, s32, 25856000
    s_addc_u32 s45, s33, 0
    s_mov_b32 s46, 2048
    s_mov_b32 s47, 0x20000
    s_add_u32 s48, s32, 25865792
    s_addc_u32 s49, s33, 0
    s_mov_b32 s50, 63840
    s_mov_b32 s51, 0x20000
    s_add_u32 s52, s32, 25859648
    s_addc_u32 s53, s33, 0
    s_mov_b32 s54, 6144
    s_mov_b32 s55, 0x20000
    v_mul_u32_u24 v5, 384, v4
    v_mul_u32_u24 v6, 96, v3
    v_add_u32 v5, v5, v6
    buffer_load_dwordx4 v[8:11], v5, s[36:39], 0 offen offset:0
    buffer_load_dwordx4 v[12:15], v5, s[36:39], 0 offen offset:16
    buffer_load_dwordx4 v[16:19], v5, s[36:39], 0 offen offset:32
    buffer_load_dwordx4 v[20:23], v5, s[36:39], 0 offen offset:48
    buffer_load_dwordx4 v[24:27], v5, s[36:39], 0 offen offset:64
    buffer_load_dwordx4 v[28:31], v5, s[36:39], 0 offen offset:80
    v_lshlrev_b32 v6, 1, v4
    buffer_load_ushort v7, v6, s[40:43], 0 offen
    s_cmp_lg_u32 s5, 5
    s_cbranch_scc1 K1G_NOWF
    s_cmp_ge_u32 s3, 3
    s_cbranch_scc1 K1G_NOWF
    v_lshrrev_b32 v40, 5, v2
    v_mul_u32_u24 v40, 3072, v40
    v_and_b32 v41, 31, v2
    v_lshl_add_u32 v40, v41, 2, v40
    s_lshl_b32 s6, s3, 7
    buffer_load_dword v44, v40, s[36:39], s6 offen offset:0
    buffer_load_dword v45, v40, s[36:39], s6 offen offset:384
    buffer_load_dword v46, v40, s[36:39], s6 offen offset:768
    buffer_load_dword v47, v40, s[36:39], s6 offen offset:1152
    buffer_load_dword v48, v40, s[36:39], s6 offen offset:1536
    buffer_load_dword v49, v40, s[36:39], s6 offen offset:1920
    buffer_load_dword v50, v40, s[36:39], s6 offen offset:2304
    buffer_load_dword v51, v40, s[36:39], s6 offen offset:2688
    s_mov_b32 s10, 0x05040100
    s_mov_b32 s11, 0x07060302
    s_waitcnt vmcnt(0)
    v_perm_b32 v52, v45, v44, s10
    v_perm_b32 v53, v47, v46, s10
    v_perm_b32 v54, v49, v48, s10
    v_perm_b32 v55, v51, v50, s10
    v_perm_b32 v56, v45, v44, s11
    v_perm_b32 v57, v47, v46, s11
    v_perm_b32 v58, v49, v48, s11
    v_perm_b32 v59, v51, v50, s11
    v_lshlrev_b32 v40, 4, v2
    s_lshl_b32 s6, s3, 11
    buffer_store_dwordx4 v[52:55], v40, s[52:55], s6 offen
    buffer_store_dwordx4 v[56:59], v40, s[52:55], s6 offen offset:1024
K1G_NOWF:
    s_mov_b32 s6, 0x7fff7fff
    s_waitcnt vmcnt(0)
    v_and_b32 v8, s6, v8
    v_and_b32 v9, s6, v9
    v_and_b32 v10, s6, v10
    v_and_b32 v11, s6, v11
    v_and_b32 v12, s6, v12
    v_and_b32 v13, s6, v13
    v_and_b32 v14, s6, v14
    v_and_b32 v15, s6, v15
    v_and_b32 v16, s6, v16
    v_and_b32 v17, s6, v17
    v_and_b32 v18, s6, v18
    v_and_b32 v19, s6, v19
    v_and_b32 v20, s6, v20
    v_and_b32 v21, s6, v21
    v_and_b32 v22, s6, v22
    v_and_b32 v23, s6, v23
    v_and_b32 v24, s6, v24
    v_and_b32 v25, s6, v25
    v_and_b32 v26, s6, v26
    v_and_b32 v27, s6, v27
    v_and_b32 v28, s6, v28
    v_and_b32 v29, s6, v29
    v_and_b32 v30, s6, v30
    v_and_b32 v31, s6, v31
    v_pk_max_u16 v8, v8, v9
    v_pk_max_u16 v8, v8, v10
    v_pk_max_u16 v8, v8, v11
    v_pk_max_u16 v8, v8, v12
    v_pk_max_u16 v8, v8, v13
    v_pk_max_u16 v8, v8, v14
    v_pk_max_u16 v8, v8, v15
    v_pk_max_u16 v8, v8, v16
    v_pk_max_u16 v8, v8, v17
    v_pk_max_u16 v8, v8, v18
    v_pk_max_u16 v8, v8, v19
    v_pk_max_u16 v8, v8, v20
    v_pk_max_u16 v8, v8, v21
    v_pk_max_u16 v8, v8, v22
    v_pk_max_u16 v8, v8, v23
    v_pk_max_u16 v8, v8, v24
    v_pk_max_u16 v8, v8, v25
    v_pk_max_u16 v8, v8, v26
    v_pk_max_u16 v8, v8, v27
    v_pk_max_u16 v8, v8, v28
    v_pk_max_u16 v8, v8, v29
    v_pk_max_u16 v8, v8, v30
    v_pk_max_u16 v8, v8, v31
    v_lshlrev_b32 v9, 16, v8
    v_and_b32 v8, s4, v8
    v_max_u32 v8, v8, v9
    v_mov_b32 v9, v8
    s_nop 1
    v_permlane32_swap_b32 v8, v9
    v_max_u32 v8, v8, v9
    v_mov_b32 v9, v8
    s_nop 1
    v_permlane16_swap_b32 v8, v9
    v_max_u32 v8, v8, v9
    v_max_u32 v8, 0x0d800000, v8
    v_lshlrev_b32 v7, 16, v7
    v_lshrrev_b32 v10, 4, v0
    s_lshl_b32 s6, s5, 6
    v_add_u32 v10, s6, v10
    v_cmp_eq_u32 s[12:13], 0, v4
    s_mov_b32 s8, 0x3e22f983
    s_mov_b32 s9, 0x31dc9c88
    s_mov_b32 s14, 0
K1G_LOOP:
    v_sub_u32 v11, 0x409c, v10
    v_lshlrev_b32 v11, 16, v11
    v_mul_f32 v12, v11, v7
    v_cvt_pk_bf16_f32 v12, v12, v12
    v_and_b32 v12, s4, v12
    v_and_b32 v21, 0x80000000, v12
    v_and_b32 v12, 0x7fffffff, v12
    v_mul_f32 v13, s8, v12
    v_fma_f32 v20, v12, s8, -v13
    v_fma_f32 v20, v12, s9, v20
    v_fract_f32 v13, v13
    v_add_f32 v13, v13, v20
    v_sin_f32 v13, v13
    v_rcp_f32 v14, v11
    v_xor_b32 v13, v21, v13
    v_cvt_pk_bf16_f32 v13, v13, v13
    v_and_b32 v13, s4, v13
    v_mul_f32 v13, v13, v14
    v_cvt_pk_bf16_f32 v13, v13, v13
    v_and_b32 v13, s4, v13
    v_mul_f32 v15, 0x40490fdb, v11
    v_cvt_pk_bf16_f32 v15, v15, v15
    v_and_b32 v15, s4, v15
    v_mul_f32 v15, 0x3e4ccccd, v15
    v_cvt_pk_bf16_f32 v15, v15, v15
    v_and_b32 v15, s4, v15
    v_mul_f32 v16, s8, v15
    v_fma_f32 v20, v15, s8, -v16
    v_fma_f32 v20, v15, s9, v20
    v_fract_f32 v16, v16
    v_add_f32 v16, v16, v20
    v_cos_f32 v16, v16
    s_nop 0
    v_cvt_pk_bf16_f32 v16, v16, v16
    v_and_b32 v16, s4, v16
    v_add_f32 v16, 1.0, v16
    v_cvt_pk_bf16_f32 v16, v16, v16
    v_and_b32 v16, s4, v16
    v_mul_f32 v16, 0.5, v16
    v_mul_f32 v13, v13, v16
    v_cvt_pk_bf16_f32 v13, v13, v13
    v_and_b32 v13, s4, v13
    v_mul_f32 v17, abs(v13), v8
    s_nop 1
    v_add_f32_dpp v17, v17, v17 row_ror:8 row_mask:0xf bank_mask:0xf
    s_nop 1
    v_add_f32_dpp v17, v17, v17 row_ror:4 row_mask:0xf bank_mask:0xf
    s_nop 1
    v_add_f32_dpp v17, v17, v17 row_ror:2 row_mask:0xf bank_mask:0xf
    s_nop 1
    v_add_f32_dpp v17, v17, v17 row_ror:1 row_mask:0xf bank_mask:0xf
    v_lshrrev_b32 v17, 23, v17
    v_sub_u32 v18, 127, v17
    v_ldexp_f32 v13, v13, v18
    v_lshrrev_b32 v13, 16, v13
    v_lshl_add_u32 v19, v10, 5, v6
    buffer_store_short v13, v19, s[48:51], 0 offen
    s_mov_b64 exec, s[12:13]
    buffer_store_byte v17, v10, s[44:47], 0 offen
    s_mov_b64 exec, -1
    v_add_u32 v10, 384, v10
    s_add_u32 s14, s14, 1
    s_cmp_lt_u32 s14, 6
    s_cbranch_scc1 K1G_LOOP
K1_END:
    s_endpgm
.globl painn_main_kernel
.p2align 8
.type painn_main_kernel,@function
painn_main_kernel:
    s_cmp_ge_u32 s2, 256
    s_cbranch_scc1 K2_END
    s_load_dwordx2 s[16:17], s[0:1], 0
    s_load_dwordx2 s[18:19], s[0:1], 64
    s_load_dwordx2 s[20:21], s[0:1], 80
    v_lshrrev_b32 v8, 6, v0
    v_and_b32 v7, 63, v0
    v_readfirstlane_b32 s3, v8
    v_lshlrev_b32 v7, 4, v7
    s_cmp_lg_u32 s3, 7
    s_cbranch_scc1 K2_NOCT
    s_getpc_b64 s[74:75]
K2_PC:
    s_add_u32 s74, s74, painn_main_kernel-K2_PC
    s_addc_u32 s75, s75, -1
    s_lshr_b32 s76, s2, 3
    s_mul_i32 s76, s76, 640
    v_and_b32 v255, 63, v0
    v_lshlrev_b32 v255, 7, v255
    v_add_u32 v255, s76, v255
    v_min_u32 v255, K2_END-painn_main_kernel, v255
    s_mov_b64 exec, 0x1f
    global_load_dword v255, v255, s[74:75]
    s_mov_b64 exec, -1
K2_NOCT:
    s_and_b32 s62, s2, 7
    s_lshl_b32 s62, s62, 5
    s_lshr_b32 s5, s2, 3
    s_add_u32 s62, s62, s5
    s_lshl_b32 s5, s62, 2
    s_mov_b32 s4, 0xffff0000
    s_mov_b32 s11, 0
    s_mov_b32 s10, 40
    s_lshl_b32 s53, s3, 6
    s_mul_i32 s6, s62, 98
    s_add_u32 s7, s6, 98
    s_min_u32 s7, s7, 25000
    s_lshl_b32 s7, s7, 9
    s_lshl_b32 s56, s6, 9
    s_waitcnt lgkmcnt(0)
    s_add_u32 s24, s20, 25600000
    s_addc_u32 s25, s21, 0
    s_mov_b32 s26, 128000
    s_mov_b32 s27, 0x20000
    s_mov_b32 s40, s16
    s_mov_b32 s41, s17
    s_mov_b32 s42, s7
    s_mov_b32 s43, 0x20000
    s_mov_b32 s44, s18
    s_mov_b32 s45, s19
    s_mov_b32 s46, s7
    s_mov_b32 s47, 0x20000
K2_ROUND:
    v_lshrrev_b32 v12, 4, v7
    v_add_u32 v12, s53, v12
    v_lshrrev_b32 v8, 2, v12
    v_lshlrev_b32 v9, 10, v8
    buffer_load_dword v13, v9, s[24:27], s5 offen
    s_add_u32 s28, s20, 25856000
    s_addc_u32 s29, s21, 0
    s_mov_b32 s30, 73728
    s_mov_b32 s31, 0x20000
    s_lshr_b32 s8, s2, 3
    s_add_u32 s8, s8, s3
    s_and_b32 s9, s8, 31
    s_lshl_b32 s9, s9, 10
    s_add_u32 m0, s9, 4096
    s_nop 0
    buffer_load_dwordx4 v7, s[28:31], s9 offen lds
    s_add_u32 s8, s8, 8
    s_and_b32 s9, s8, 31
    s_lshl_b32 s9, s9, 10
    s_add_u32 m0, s9, 4096
    s_nop 0
    buffer_load_dwordx4 v7, s[28:31], s9 offen lds
    s_add_u32 s8, s8, 8
    s_and_b32 s9, s8, 31
    s_lshl_b32 s9, s9, 10
    s_add_u32 m0, s9, 4096
    s_nop 0
    buffer_load_dwordx4 v7, s[28:31], s9 offen lds
    s_add_u32 s8, s8, 8
    s_and_b32 s9, s8, 31
    s_lshl_b32 s9, s9, 10
    s_add_u32 m0, s9, 4096
    s_nop 0
    buffer_load_dwordx4 v7, s[28:31], s9 offen lds
    s_add_u32 s8, s8, 8
    s_add_u32 s32, s20, 16000000
    s_addc_u32 s33, s21, 0
    s_mov_b32 s34, 9600000
    s_mov_b32 s35, 0x20000
    s_mov_b32 s36, s20
    s_mov_b32 s37, s21
    s_mov_b32 s38, 800000
    s_mov_b32 s39, 0x20000
    s_or_b32 s37, s37, 0x100000
    s_add_u32 s48, s20, 12800000
    s_addc_u32 s49, s21, 0
    s_mov_b32 s50, 800000
    s_mov_b32 s51, 0x20000
    s_or_b32 s49, s49, 0x40000
    v_and_b32 v16, 3, v12
    v_mul_u32_u24 v15, 6400, v8
    v_add3_u32 v15, v15, v16, s11
    v_lshlrev_b32 v8, 2, v12
    v_mov_b32 v9, 0
    ds_write_b32 v8, v9 offset:0
    s_cmp_ge_u32 s3, 2
    s_cbranch_scc1 K2_NODEG
    v_sub_u32 v9, 127, v12
    ds_write_b32 v8, v9 offset:2048
K2_NODEG:
    s_waitcnt vmcnt(4)
    v_lshrrev_b32 v14, 16, v13
    v_and_b32 v8, 0xffff, v13
    v_add_u32 v15, v15, v8
    v_mul_u32_u24 v15, 12, v15
    v_subrev_u32 v13, s11, v14
    v_min_i32 v14, s10, v13
    v_sub_u32 v14, v14, v16
    v_cmp_lt_i32 s[64:65], 0, v14
    v_cmp_lt_i32 s[66:67], 4, v14
    v_cmp_lt_i32 s[68:69], 8, v14
    v_cmp_lt_i32 s[70:71], 12, v14
    v_cmp_lt_i32 s[72:73], 16, v14
    v_cmp_lt_i32 s[74:75], 20, v14
    v_cmp_lt_i32 s[76:77], 24, v14
    v_cmp_lt_i32 s[78:79], 28, v14
    v_cmp_lt_i32 s[80:81], 32, v14
    v_cmp_lt_i32 s[82:83], 36, v14
    s_mov_b64 exec, s[64:65]
    s_cbranch_execz K2_LDDONE
    buffer_load_dwordx3 v[112:114], v15, s[32:35], 0 offen offset:0
    s_mov_b64 exec, s[66:67]
    buffer_load_dwordx3 v[116:118], v15, s[32:35], 0 offen offset:48
    s_mov_b64 exec, s[68:69]
    s_cbranch_execz K2_LDDONE
    buffer_load_dwordx3 v[120:122], v15, s[32:35], 0 offen offset:96
    s_mov_b64 exec, s[70:71]
    buffer_load_dwordx3 v[124:126], v15, s[32:35], 0 offen offset:144
    s_mov_b64 exec, s[72:73]
    s_cbranch_execz K2_LDDONE
    buffer_load_dwordx3 v[128:130], v15, s[32:35], 0 offen offset:192
    s_mov_b64 exec, s[74:75]
    buffer_load_dwordx3 v[132:134], v15, s[32:35], 0 offen offset:240
    s_mov_b64 exec, s[76:77]
    s_cbranch_execz K2_LDDONE
    buffer_load_dwordx3 v[136:138], v15, s[32:35], 0 offen offset:288
    s_mov_b64 exec, s[78:79]
    buffer_load_dwordx3 v[140:142], v15, s[32:35], 0 offen offset:336
    s_mov_b64 exec, s[80:81]
    s_cbranch_execz K2_LDDONE
    buffer_load_dwordx3 v[144:146], v15, s[32:35], 0 offen offset:384
    s_mov_b64 exec, s[82:83]
    buffer_load_dwordx3 v[148:150], v15, s[32:35], 0 offen offset:432
K2_LDDONE:
    s_mov_b64 exec, -1
    v_and_b32 v0, 0x1f0, v7
    v_lshrrev_b32 v1, 4, v0
    v_lshrrev_b32 v2, 5, v0
    v_sub_u32 v2, 15, v2
    v_lshl_or_b32 v2, v2, 16, v2
    v_bfe_u32 v3, v7, 4, 1
    v_mul_u32_u24 v3, 0x5555, v3
    v_add_u32 v3, 0x8888, v3
    v_lshrrev_b32 v6, 9, v7
    v_lshlrev_b32 v6, 4, v6
    v_lshlrev_b32 v11, 2, v1
    s_lshl_b32 s63, s3, 3
    s_mov_b32 s54, 0xffe0
    s_mov_b32 s55, 77824
    v_mov_b32 v48, 0
    v_mov_b32 v49, 0
    v_mov_b32 v50, 0
    v_mov_b32 v51, 0
    v_mov_b32 v52, 0
    v_mov_b32 v53, 0
    v_mov_b32 v54, 0
    v_mov_b32 v55, 0
    v_mov_b32 v56, 0
    v_mov_b32 v57, 0
    v_mov_b32 v58, 0
    v_mov_b32 v59, 0
    v_mov_b32 v60, 0
    v_mov_b32 v61, 0
    v_mov_b32 v62, 0
    v_mov_b32 v63, 0
    v_mov_b32 v64, 0
    v_mov_b32 v65, 0
    v_mov_b32 v66, 0
    v_mov_b32 v67, 0
    v_mov_b32 v68, 0
    v_mov_b32 v69, 0
    v_mov_b32 v70, 0
    v_mov_b32 v71, 0
    v_mov_b32 v72, 0
    v_mov_b32 v73, 0
    v_mov_b32 v74, 0
    v_mov_b32 v75, 0
    v_mov_b32 v76, 0
    v_mov_b32 v77, 0
    v_mov_b32 v78, 0
    v_mov_b32 v79, 0
    v_mov_b32 v80, 0
    v_mov_b32 v81, 0
    v_mov_b32 v82, 0
    v_mov_b32 v83, 0
    v_mov_b32 v84, 0
    v_mov_b32 v85, 0
    v_mov_b32 v86, 0
    v_mov_b32 v87, 0
    v_mov_b32 v88, 0
    v_mov_b32 v89, 0
    v_mov_b32 v90, 0
    v_mov_b32 v91, 0
    v_mov_b32 v92, 0
    v_mov_b32 v93, 0
    v_mov_b32 v94, 0
    v_mov_b32 v95, 0
    v_mov_b32 v96, 0
    v_mov_b32 v97, 0
    v_mov_b32 v98, 0
    v_mov_b32 v99, 0
    v_mov_b32 v100, 0
    v_mov_b32 v101, 0
    v_mov_b32 v102, 0
    v_mov_b32 v103, 0
    v_mov_b32 v104, 0
    v_mov_b32 v105, 0
    v_mov_b32 v106, 0
    v_mov_b32 v107, 0
    v_mov_b32 v108, 0
    v_mov_b32 v109, 0
    v_mov_b32 v110, 0
    v_mov_b32 v111, 0
    v_mov_b32 v17, 0
    s_waitcnt lgkmcnt(0)
    s_barrier
    v_mov_b32 v8, 0
    v_mov_b32 v9, 1
    v_cmp_lt_i32 vcc, s10, v13
    s_and_b64 exec, exec, vcc
    ds_write_b32 v8, v9 offset:1084
    s_mov_b64 exec, -1
    s_cmp_eq_u32 s11, 0
    s_cbranch_scc1 K2_RW
    s_waitcnt vmcnt(0)
K2_RW:
    s_waitcnt vmcnt(0)
    s_mov_b32 s60, 0
    v_mov_b32 v28, 128
    v_mov_b32 v16, 0
    s_mov_b32 s6, 717
    s_mov_b64 exec, s[64:65]
    s_cbranch_execz K2_H1DONE
    v_bfe_u32 v18, v112, 16, 9
    ds_add_u32 v18, v28 offset:2048
    v_and_b32 v8, 0x7ff, v113
    v_sub_u32 v8, v8, s6 clamp
    v_max_u32 v17, v17, v8
    v_add_u32 v16, v16, v8
    s_mov_b64 exec, s[66:67]
    v_bfe_u32 v19, v116, 16, 9
    ds_add_u32 v19, v28 offset:2048
    v_and_b32 v8, 0x7ff, v117
    v_sub_u32 v8, v8, s6 clamp
    v_max_u32 v17, v17, v8
    v_add_u32 v16, v16, v8
    s_mov_b64 exec, s[68:69]
    s_cbranch_execz K2_H1DONE
    v_bfe_u32 v20, v120, 16, 9
    ds_add_u32 v20, v28 offset:2048
    v_and_b32 v8, 0x7ff, v121
    v_sub_u32 v8, v8, s6 clamp
    v_max_u32 v17, v17, v8
    v_add_u32 v16, v16, v8
    s_mov_b64 exec, s[70:71]
    v_bfe_u32 v21, v124, 16, 9
    ds_add_u32 v21, v28 offset:2048
    v_and_b32 v8, 0x7ff, v125
    v_sub_u32 v8, v8, s6 clamp
    v_max_u32 v17, v17, v8
    v_add_u32 v16, v16, v8
    s_mov_b64 exec, s[72:73]
    s_cbranch_execz K2_H1DONE
    v_bfe_u32 v22, v128, 16, 9
    ds_add_u32 v22, v28 offset:2048
    v_and_b32 v8, 0x7ff, v129
    v_sub_u32 v8, v8, s6 clamp
    v_max_u32 v17, v17, v8
    v_add_u32 v16, v16, v8
    s_mov_b64 exec, s[74:75]
    v_bfe_u32 v23, v132, 16, 9
    ds_add_u32 v23, v28 offset:2048
    v_and_b32 v8, 0x7ff, v133
    v_sub_u32 v8, v8, s6 clamp
    v_max_u32 v17, v17, v8
    v_add_u32 v16, v16, v8
    s_mov_b64 exec, s[76:77]
    s_cbranch_execz K2_H1DONE
    v_bfe_u32 v24, v136, 16, 9
    ds_add_u32 v24, v28 offset:2048
    v_and_b32 v8, 0x7ff, v137
    v_sub_u32 v8, v8, s6 clamp
    v_max_u32 v17, v17, v8
    v_add_u32 v16, v16, v8
    s_mov_b64 exec, s[78:79]
    v_bfe_u32 v25, v140, 16, 9
    ds_add_u32 v25, v28 offset:2048
    v_and_b32 v8, 0x7ff, v141
    v_sub_u32 v8, v8, s6 clamp
    v_max_u32 v17, v17, v8
    v_add_u32 v16, v16, v8
    s_mov_b64 exec, s[80:81]
    s_cbranch_execz K2_H1DONE
    v_bfe_u32 v26, v144, 16, 9
    ds_add_u32 v26, v28 offset:2048
    v_and_b32 v8, 0x7ff, v145
    v_sub_u32 v8, v8, s6 clamp
    v_max_u32 v17, v17, v8
    v_add_u32 v16, v16, v8
    s_mov_b64 exec, s[82:83]
    v_bfe_u32 v27, v148, 16, 9
    ds_add_u32 v27, v28 offset:2048
    v_and_b32 v8, 0x7ff, v149
    v_sub_u32 v8, v8, s6 clamp
    v_max_u32 v17, v17, v8
    v_add_u32 v16, v16, v8
K2_H1DONE:
    s_mov_b64 exec, -1
    v_cmp_ne_u32 vcc, 0, v17
    s_cbranch_vccnz K2_COLD
K2_NOCOLD:
    s_cmp_lg_u32 s11, 0
    s_cbranch_scc1 K2_SVDONE0
    s_lshl_b32 s8, s3, 10
    s_add_u32 s9, s8, s56
    s_cmp_lg_u32 s3, 0
    s_cbranch_scc1 K2_SVDONE0A
    s_add_u32 m0, s8, 162816
    s_add_u32 s61, s9, 49152
    buffer_load_dwordx4 v7, s[40:43], s61 offen  lds
K2_SVDONE0A:
    s_add_u32 m0, s8, 113664
    s_add_u32 s61, s9, 0
    buffer_load_dwordx4 v7, s[40:43], s61 offen  lds
    s_add_u32 m0, s8, 121856
    s_add_u32 s61, s9, 8192
    buffer_load_dwordx4 v7, s[40:43], s61 offen  lds
    s_add_u32 m0, s8, 130048
    s_add_u32 s61, s9, 16384
    buffer_load_dwordx4 v7, s[40:43], s61 offen  lds
    s_add_u32 m0, s8, 138240
    s_add_u32 s61, s9, 24576
    buffer_load_dwordx4 v7, s[40:43], s61 offen  lds
    s_add_u32 m0, s8, 146432
    s_add_u32 s61, s9, 32768
    buffer_load_dwordx4 v7, s[40:43], s61 offen  lds
    s_add_u32 m0, s8, 154624
    s_add_u32 s61, s9, 40960
    buffer_load_dwordx4 v7, s[40:43], s61 offen  lds
K2_SVDONE0:
    v_lshrrev_b32 v31, 2, v7
    v_mov_b32 v8, s53
    v_mov_b32 v44, 0
    v_mov_b32 v45, 0
    s_waitcnt lgkmcnt(0)
    s_barrier
    ds_read2st64_b32 v[208:209], v31 offset0:8 offset1:9
    ds_read_b128 v[192:195], v8 offset:2048
    ds_read_b128 v[196:199], v8 offset:2064
    ds_read_b128 v[200:203], v8 offset:2080
    ds_read_b128 v[204:207], v8 offset:2096
    s_waitcnt lgkmcnt(3)
    v_cmp_gt_u32 vcc, v192, v208
    v_cmp_gt_u32 s[6:7], v192, v209
    v_cmp_gt_u32 s[8:9], v193, v208
    v_cmp_gt_u32 s[58:59], v193, v209
    v_addc_co_u32 v44, vcc, 0, v44, vcc
    v_addc_co_u32 v45, s[6:7], 0, v45, s[6:7]
    v_addc_co_u32 v44, s[8:9], 0, v44, s[8:9]
    v_addc_co_u32 v45, s[58:59], 0, v45, s[58:59]
    v_cmp_gt_u32 vcc, v194, v208
    v_cmp_gt_u32 s[6:7], v194, v209
    v_cmp_gt_u32 s[8:9], v195, v208
    v_cmp_gt_u32 s[58:59], v195, v209
    v_addc_co_u32 v44, vcc, 0, v44, vcc
    v_addc_co_u32 v45, s[6:7], 0, v45, s[6:7]
    v_addc_co_u32 v44, s[8:9], 0, v44, s[8:9]
    v_addc_co_u32 v45, s[58:59], 0, v45, s[58:59]
    s_waitcnt lgkmcnt(2)
    v_cmp_gt_u32 vcc, v196, v208
    v_cmp_gt_u32 s[6:7], v196, v209
    v_cmp_gt_u32 s[8:9], v197, v208
    v_cmp_gt_u32 s[58:59], v197, v209
    v_addc_co_u32 v44, vcc, 0, v44, vcc
    v_addc_co_u32 v45, s[6:7], 0, v45, s[6:7]
    v_addc_co_u32 v44, s[8:9], 0, v44, s[8:9]
    v_addc_co_u32 v45, s[58:59], 0, v45, s[58:59]
    v_cmp_gt_u32 vcc, v198, v208
    v_cmp_gt_u32 s[6:7], v198, v209
    v_cmp_gt_u32 s[8:9], v199, v208
    v_cmp_gt_u32 s[58:59], v199, v209
    v_addc_co_u32 v44, vcc, 0, v44, vcc
    v_addc_co_u32 v45, s[6:7], 0, v45, s[6:7]
    v_addc_co_u32 v44, s[8:9], 0, v44, s[8:9]
    v_addc_co_u32 v45, s[58:59], 0, v45, s[58:59]
    s_waitcnt lgkmcnt(1)
    v_cmp_gt_u32 vcc, v200, v208
    v_cmp_gt_u32 s[6:7], v200, v209
    v_cmp_gt_u32 s[8:9], v201, v208
    v_cmp_gt_u32 s[58:59], v201, v209
    v_addc_co_u32 v44, vcc, 0, v44, vcc
    v_addc_co_u32 v45, s[6:7], 0, v45, s[6:7]
    v_addc_co_u32 v44, s[8:9], 0, v44, s[8:9]
    v_addc_co_u32 v45, s[58:59], 0, v45, s[58:59]
    v_cmp_gt_u32 vcc, v202, v208
    v_cmp_gt_u32 s[6:7], v202, v209
    v_cmp_gt_u32 s[8:9], v203, v208
    v_cmp_gt_u32 s[58:59], v203, v209
    v_addc_co_u32 v44, vcc, 0, v44, vcc
    v_addc_co_u32 v45, s[6:7], 0, v45, s[6:7]
    v_addc_co_u32 v44, s[8:9], 0, v44, s[8:9]
    v_addc_co_u32 v45, s[58:59], 0, v45, s[58:59]
    s_waitcnt lgkmcnt(0)
    v_cmp_gt_u32 vcc, v204, v208
    v_cmp_gt_u32 s[6:7], v204, v209
    v_cmp_gt_u32 s[8:9], v205, v208
    v_cmp_gt_u32 s[58:59], v205, v209
    v_addc_co_u32 v44, vcc, 0, v44, vcc
    v_addc_co_u32 v45, s[6:7], 0, v45, s[6:7]
    v_addc_co_u32 v44, s[8:9], 0, v44, s[8:9]
    v_addc_co_u32 v45, s[58:59], 0, v45, s[58:59]
    v_cmp_gt_u32 vcc, v206, v208
    v_cmp_gt_u32 s[6:7], v206, v209
    v_cmp_gt_u32 s[8:9], v207, v208
    v_cmp_gt_u32 s[58:59], v207, v209
    v_addc_co_u32 v44, vcc, 0, v44, vcc
    v_addc_co_u32 v45, s[6:7], 0, v45, s[6:7]
    v_addc_co_u32 v44, s[8:9], 0, v44, s[8:9]
    v_addc_co_u32 v45, s[58:59], 0, v45, s[58:59]
    ds_add_u32 v31, v44 offset:1536
    ds_add_u32 v31, v45 offset:1792
    s_waitcnt lgkmcnt(0)
    s_barrier
    s_mov_b64 exec, s[64:65]
    s_cbranch_execz K2_H2DONE
    ds_read_b32 v18, v18 offset:1536
    s_mov_b64 exec, s[66:67]
    ds_read_b32 v19, v19 offset:1536
    s_mov_b64 exec, s[68:69]
    s_cbranch_execz K2_H2DONE
    ds_read_b32 v20, v20 offset:1536
    s_mov_b64 exec, s[70:71]
    ds_read_b32 v21, v21 offset:1536
    s_mov_b64 exec, s[72:73]
    s_cbranch_execz K2_H2DONE
    ds_read_b32 v22, v22 offset:1536
    s_mov_b64 exec, s[74:75]
    ds_read_b32 v23, v23 offset:1536
    s_mov_b64 exec, s[76:77]
    s_cbranch_execz K2_H2DONE
    ds_read_b32 v24, v24 offset:1536
    s_mov_b64 exec, s[78:79]
    ds_read_b32 v25, v25 offset:1536
    s_mov_b64 exec, s[80:81]
    s_cbranch_execz K2_H2DONE
    ds_read_b32 v26, v26 offset:1536
    s_mov_b64 exec, s[82:83]
    ds_read_b32 v27, v27 offset:1536
K2_H2DONE:
    s_mov_b64 exec, -1
    s_cmp_lg_u32 s3, 7
    s_cbranch_scc1 K2_NOINV
    ds_read2st64_b32 v[44:45], v31 offset0:6 offset1:7
    v_lshlrev_b32 v29, 5, v7
    v_add_u32 v30, 0x8000, v29
    s_waitcnt lgkmcnt(0)
    v_lshlrev_b32 v44, 2, v44
    v_lshlrev_b32 v45, 2, v45
    ds_write_b32 v44, v29 offset:3584
    ds_write_b32 v45, v30 offset:3584
K2_NOINV:
    s_waitcnt lgkmcnt(0)
    s_mov_b64 exec, s[64:65]
    s_cbranch_execz K2_HDONE
    v_bfe_i32 v8, v18, 3, 1
    v_xor_b32 v8, v8, v18
    v_and_b32 v8, 7, v8
    v_and_b32 v18, 0x78, v18
    v_lshl_or_b32 v113, v18, 8, v113
    v_lshrrev_b32 v18, 25, v112
    v_lshl_or_b32 v18, v8, 7, v18
    ds_add_rtn_u32 v115, v18, v9 offset:0
    s_mov_b64 exec, s[66:67]
    v_bfe_i32 v8, v19, 3, 1
    v_xor_b32 v8, v8, v19
    v_and_b32 v8, 7, v8
    v_and_b32 v19, 0x78, v19
    v_lshl_or_b32 v117, v19, 8, v117
    v_lshrrev_b32 v19, 25, v116
    v_lshl_or_b32 v19, v8, 7, v19
    ds_add_rtn_u32 v119, v19, v9 offset:0
    s_mov_b64 exec, s[68:69]
    s_cbranch_execz K2_HDONE
    v_bfe_i32 v8, v20, 3, 1
    v_xor_b32 v8, v8, v20
    v_and_b32 v8, 7, v8
    v_and_b32 v20, 0x78, v20
    v_lshl_or_b32 v121, v20, 8, v121
    v_lshrrev_b32 v20, 25, v120
    v_lshl_or_b32 v20, v8, 7, v20
    ds_add_rtn_u32 v123, v20, v9 offset:0
    s_mov_b64 exec, s[70:71]
    v_bfe_i32 v8, v21, 3, 1
    v_xor_b32 v8, v8, v21
    v_and_b32 v8, 7, v8
    v_and_b32 v21, 0x78, v21
    v_lshl_or_b32 v125, v21, 8, v125
    v_lshrrev_b32 v21, 25, v124
    v_lshl_or_b32 v21, v8, 7, v21
    ds_add_rtn_u32 v127, v21, v9 offset:0
    s_mov_b64 exec, s[72:73]
    s_cbranch_execz K2_HDONE
    v_bfe_i32 v8, v22, 3, 1
    v_xor_b32 v8, v8, v22
    v_and_b32 v8, 7, v8
    v_and_b32 v22, 0x78, v22
    v_lshl_or_b32 v129, v22, 8, v129
    v_lshrrev_b32 v22, 25, v128
    v_lshl_or_b32 v22, v8, 7, v22
    ds_add_rtn_u32 v131, v22, v9 offset:0
    s_mov_b64 exec, s[74:75]
    v_bfe_i32 v8, v23, 3, 1
    v_xor_b32 v8, v8, v23
    v_and_b32 v8, 7, v8
    v_and_b32 v23, 0x78, v23
    v_lshl_or_b32 v133, v23, 8, v133
    v_lshrrev_b32 v23, 25, v132
    v_lshl_or_b32 v23, v8, 7, v23
    ds_add_rtn_u32 v135, v23, v9 offset:0
    s_mov_b64 exec, s[76:77]
    s_cbranch_execz K2_HDONE
    v_bfe_i32 v8, v24, 3, 1
    v_xor_b32 v8, v8, v24
    v_and_b32 v8, 7, v8
    v_and_b32 v24, 0x78, v24
    v_lshl_or_b32 v137, v24, 8, v137
    v_lshrrev_b32 v24, 25, v136
    v_lshl_or_b32 v24, v8, 7, v24
    ds_add_rtn_u32 v139, v24, v9 offset:0
    s_mov_b64 exec, s[78:79]
    v_bfe_i32 v8, v25, 3, 1
    v_xor_b32 v8, v8, v25
    v_and_b32 v8, 7, v8
    v_and_b32 v25, 0x78, v25
    v_lshl_or_b32 v141, v25, 8, v141
    v_lshrrev_b32 v25, 25, v140
    v_lshl_or_b32 v25, v8, 7, v25
    ds_add_rtn_u32 v143, v25, v9 offset:0
    s_mov_b64 exec, s[80:81]
    s_cbranch_execz K2_HDONE
    v_bfe_i32 v8, v26, 3, 1
    v_xor_b32 v8, v8, v26
    v_and_b32 v8, 7, v8
    v_and_b32 v26, 0x78, v26
    v_lshl_or_b32 v145, v26, 8, v145
    v_lshrrev_b32 v26, 25, v144
    v_lshl_or_b32 v26, v8, 7, v26
    ds_add_rtn_u32 v147, v26, v9 offset:0
    s_mov_b64 exec, s[82:83]
    v_bfe_i32 v8, v27, 3, 1
    v_xor_b32 v8, v8, v27
    v_and_b32 v8, 7, v8
    v_and_b32 v27, 0x78, v27
    v_lshl_or_b32 v149, v27, 8, v149
    v_lshrrev_b32 v27, 25, v148
    v_lshl_or_b32 v27, v8, 7, v27
    ds_add_rtn_u32 v151, v27, v9 offset:0
K2_HDONE:
    s_mov_b64 exec, -1
    s_waitcnt lgkmcnt(0)
    s_barrier
    ds_read_b128 v[32:35], v7 offset:0
    v_mov_b32 v8, 0
    ds_read_b32 v43, v8 offset:1084
    v_and_b32 v8, 0x70, v7
    v_cmp_eq_u32 vcc, 0x70, v8
    s_waitcnt lgkmcnt(0)
    v_readfirstlane_b32 s12, v43
    v_add_u32 v40, v32, v33
    v_add3_u32 v40, v40, v34, v35
    s_nop 1
    v_add_u32_dpp v41, v40, v40 quad_perm:[1,0,3,2] row_mask:0xf bank_mask:0xf
    s_nop 1
    v_add_u32_dpp v41, v41, v41 quad_perm:[2,3,0,1] row_mask:0xf bank_mask:0xf
    s_nop 1
    v_add_u32_dpp v41, v41, v41 row_half_mirror row_mask:0xf bank_mask:0xf
    v_max_u32 v8, 1, v41
    v_add_u32 v8, 31, v8
    v_and_b32 v8, -32, v8
    v_lshrrev_b32 v43, 5, v8
    v_sub_u32 v8, v8, v41
    v_min_u32 v9, 16, v8
    v_and_b32 v9, 16, v9
    v_cndmask_b32 v8, 0, v8, vcc
    v_add_u32 v40, v40, v8
    v_mov_b32 v42, v40
    v_sub_u32 v40, v40, v9
    s_nop 0
    v_add_u32_dpp v42, v42, v42 row_shr:1 row_mask:0xf bank_mask:0xf bound_ctrl:0
    s_nop 1
    v_add_u32_dpp v42, v42, v42 row_shr:2 row_mask:0xf bank_mask:0xf bound_ctrl:0
    s_nop 1
    v_add_u32_dpp v42, v42, v42 row_shr:4 row_mask:0xf bank_mask:0xf bound_ctrl:0
    s_nop 1
    v_add_u32_dpp v42, v42, v42 row_shr:8 row_mask:0xf bank_mask:0xf bound_ctrl:0
    s_nop 1
    v_add_u32_dpp v42, v42, v42 row_bcast:15 row_mask:0xa bank_mask:0xf
    s_nop 1
    v_add_u32_dpp v42, v42, v42 row_bcast:31 row_mask:0xc bank_mask:0xf
    v_sub_u32 v36, v42, v40
    v_add_u32 v37, v36, v32
    v_add_u32 v38, v37, v33
    v_add_u32 v39, v38, v34
    ds_write_b128 v7, v[36:39] offset:2560
    s_mov_b64 exec, s[64:65]
    s_cbranch_execz K2_S1DONE
    ds_read_b32 v18, v18 offset:2560
    s_mov_b64 exec, s[66:67]
    ds_read_b32 v19, v19 offset:2560
    s_mov_b64 exec, s[68:69]
    s_cbranch_execz K2_S1DONE
    ds_read_b32 v20, v20 offset:2560
    s_mov_b64 exec, s[70:71]
    ds_read_b32 v21, v21 offset:2560
    s_mov_b64 exec, s[72:73]
    s_cbranch_execz K2_S1DONE
    ds_read_b32 v22, v22 offset:2560
    s_mov_b64 exec, s[74:75]
    ds_read_b32 v23, v23 offset:2560
    s_mov_b64 exec, s[76:77]
    s_cbranch_execz K2_S1DONE
    ds_read_b32 v24, v24 offset:2560
    s_mov_b64 exec, s[78:79]
    ds_read_b32 v25, v25 offset:2560
    s_mov_b64 exec, s[80:81]
    s_cbranch_execz K2_S1DONE
    ds_read_b32 v26, v26 offset:2560
    s_mov_b64 exec, s[82:83]
    ds_read_b32 v27, v27 offset:2560
K2_S1DONE:
    s_mov_b64 exec, -1
    v_readlane_b32 s6, v42, 63
    v_readlane_b32 s13, v36, s63
    v_readlane_b32 s14, v41, s63
    v_readlane_b32 s15, v43, s63
    v_min_u32_dpp v43, v43, v43 row_ror:8 row_mask:0xf bank_mask:0xf
    s_cmp_le_u32 s6, 2560
    s_cbranch_scc0 K2_RETRY
    v_readlane_b32 s22, v43, 0
    v_readlane_b32 s23, v43, 16
    v_readlane_b32 s8, v43, 32
    v_readlane_b32 s9, v43, 48
    s_and_b32 s57, s13, 16
    s_lshr_b32 s13, s13, 5
    s_mul_i32 s13, s13, 448
    s_add_u32 s13, s13, 77824
    s_min_u32 s22, s22, s23
    s_min_u32 s8, s8, s9
    s_min_u32 s22, s22, s8
    s_mov_b32 s23, 0
    v_mov_b32 v17, 448
    s_waitcnt lgkmcnt(0)
    s_mov_b64 exec, s[64:65]
    s_cbranch_execz K2_S2DONE
    v_add_u32 v18, v18, v115
    v_lshrrev_b32 v8, 5, v18
    v_mad_u32_u24 v8, v8, v17, s55
    v_and_b32 v18, 31, v18
    v_lshl_add_u32 v9, v18, 1, v8
    v_lshl_add_u32 v8, v18, 3, v8
    ds_write_b16 v9, v112 offset:0
    ds_write2_b32 v8, v113, v114 offset0:16 offset1:17
    s_mov_b64 exec, s[66:67]
    v_add_u32 v19, v19, v119
    v_lshrrev_b32 v8, 5, v19
    v_mad_u32_u24 v8, v8, v17, s55
    v_and_b32 v19, 31, v19
    v_lshl_add_u32 v9, v19, 1, v8
    v_lshl_add_u32 v8, v19, 3, v8
    ds_write_b16 v9, v116 offset:0
    ds_write2_b32 v8, v117, v118 offset0:16 offset1:17
    s_mov_b64 exec, s[68:69]
    s_cbranch_execz K2_S2DONE
    v_add_u32 v20, v20, v123
    v_lshrrev_b32 v8, 5, v20
    v_mad_u32_u24 v8, v8, v17, s55
    v_and_b32 v20, 31, v20
    v_lshl_add_u32 v9, v20, 1, v8
    v_lshl_add_u32 v8, v20, 3, v8
    ds_write_b16 v9, v120 offset:0
    ds_write2_b32 v8, v121, v122 offset0:16 offset1:17
    s_mov_b64 exec, s[70:71]
    v_add_u32 v21, v21, v127
    v_lshrrev_b32 v8, 5, v21
    v_mad_u32_u24 v8, v8, v17, s55
    v_and_b32 v21, 31, v21
    v_lshl_add_u32 v9, v21, 1, v8
    v_lshl_add_u32 v8, v21, 3, v8
    ds_write_b16 v9, v124 offset:0
    ds_write2_b32 v8, v125, v126 offset0:16 offset1:17
    s_mov_b64 exec, s[72:73]
    s_cbranch_execz K2_S2DONE
    v_add_u32 v22, v22, v131
    v_lshrrev_b32 v8, 5, v22
    v_mad_u32_u24 v8, v8, v17, s55
    v_and_b32 v22, 31, v22
    v_lshl_add_u32 v9, v22, 1, v8
    v_lshl_add_u32 v8, v22, 3, v8
    ds_write_b16 v9, v128 offset:0
    ds_write2_b32 v8, v129, v130 offset0:16 offset1:17
    s_mov_b64 exec, s[74:75]
    v_add_u32 v23, v23, v135
    v_lshrrev_b32 v8, 5, v23
    v_mad_u32_u24 v8, v8, v17, s55
    v_and_b32 v23, 31, v23
    v_lshl_add_u32 v9, v23, 1, v8
    v_lshl_add_u32 v8, v23, 3, v8
    ds_write_b16 v9, v132 offset:0
    ds_write2_b32 v8, v133, v134 offset0:16 offset1:17
    s_mov_b64 exec, s[76:77]
    s_cbranch_execz K2_S2DONE
    v_add_u32 v24, v24, v139
    v_lshrrev_b32 v8, 5, v24
    v_mad_u32_u24 v8, v8, v17, s55
    v_and_b32 v24, 31, v24
    v_lshl_add_u32 v9, v24, 1, v8
    v_lshl_add_u32 v8, v24, 3, v8
    ds_write_b16 v9, v136 offset:0
    ds_write2_b32 v8, v137, v138 offset0:16 offset1:17
    s_mov_b64 exec, s[78:79]
    v_add_u32 v25, v25, v143
    v_lshrrev_b32 v8, 5, v25
    v_mad_u32_u24 v8, v8, v17, s55
    v_and_b32 v25, 31, v25
    v_lshl_add_u32 v9, v25, 1, v8
    v_lshl_add_u32 v8, v25, 3, v8
    ds_write_b16 v9, v140 offset:0
    ds_write2_b32 v8, v141, v142 offset0:16 offset1:17
    s_mov_b64 exec, s[80:81]
    s_cbranch_execz K2_S2DONE
    v_add_u32 v26, v26, v147
    v_lshrrev_b32 v8, 5, v26
    v_mad_u32_u24 v8, v8, v17, s55
    v_and_b32 v26, 31, v26
    v_lshl_add_u32 v9, v26, 1, v8
    v_lshl_add_u32 v8, v26, 3, v8
    ds_write_b16 v9, v144 offset:0
    ds_write2_b32 v8, v145, v146 offset0:16 offset1:17
    s_mov_b64 exec, s[82:83]
    v_add_u32 v27, v27, v151
    v_lshrrev_b32 v8, 5, v27
    v_mad_u32_u24 v8, v8, v17, s55
    v_and_b32 v27, 31, v27
    v_lshl_add_u32 v9, v27, 1, v8
    v_lshl_add_u32 v8, v27, 3, v8
    ds_write_b16 v9, v148 offset:0
    ds_write2_b32 v8, v149, v150 offset0:16 offset1:17
K2_S2DONE:
    s_mov_b64 exec, -1
    v_add_u32 v4, s13, v6
    v_lshrrev_b32 v5, 3, v0
    v_add_u32 v5, s13, v5
    v_mul_u32_u24 v16, 28, v6
    v_add_u32 v16, s13, v16
    v_lshl_add_u32 v17, v1, 3, v16
    v_and_b32 v8, 0x130, v0
    v_bfe_u32 v9, v0, 6, 1
    v_lshl_or_b32 v8, v9, 7, v8
    v_bfe_u32 v9, v0, 7, 1
    v_lshl_or_b32 v8, v9, 6, v8
    v_lshrrev_b32 v8, 3, v8
    v_add_u32 v18, v16, v8
    v_lshrrev_b32 v8, 3, v0
    v_add_u32 v16, v16, v8
    v_lshrrev_b32 v19, 4, v7
    v_subrev_u32 v19, s57, v19
    s_mov_b32 s52, s15
    s_cmp_eq_u32 s60, 0
    s_cbranch_scc1 K2_NOCW
    s_waitcnt vmcnt(6)
    s_cmp_eq_u32 s11, 0
    s_cbranch_scc1 K2_NOCW
    s_waitcnt vmcnt(0)
K2_NOCW:
    s_waitcnt lgkmcnt(0)
    s_barrier
    ds_read_b128 v[12:15], v4 offset:0
    ds_read_b128 v[28:31], v4 offset:32
    ds_read_b128 v[32:35], v4 offset:448
    s_lshr_b32 s61, s57, 4
    s_add_u32 s61, s61, 1
K2_R1:
    ds_read_u16 v192, v16 offset:0
    ds_read_b64 v[200:201], v17 offset:64
    ds_read_u16 v193, v16 offset:896
    ds_read_b64 v[202:203], v17 offset:960
    ds_read_u16 v194, v16 offset:1792
    ds_read_b64 v[204:205], v17 offset:1856
    ds_read_u16 v195, v16 offset:2688
    ds_read_b64 v[206:207], v17 offset:2752
    s_cmp_le_u32 s52, 8
    s_cbranch_scc1 K2_R1A
    ds_read_u16 v196, v16 offset:3584
    ds_read_b64 v[208:209], v17 offset:3648
    s_cmp_le_u32 s52, 10
    s_cbranch_scc1 K2_R1A
    ds_read_u16 v197, v16 offset:4480
    ds_read_b64 v[210:211], v17 offset:4544
K2_R1A:
    s_waitcnt lgkmcnt(0)
    s_cmp_lg_u32 s61, 1
    s_cbranch_scc1 K2_FA0
    v_mad_u32_u16 v26, v12, 32, v1 op_sel:[0,0,0,0]
    buffer_load_dwordx4 v[112:115], v26, s[36:39], 0 idxen
    buffer_load_dword v176, v26, s[48:51], 0 idxen
K2_FR0:
    v_add_u32 v8, 0, v19
    v_cmp_gt_u32 s[64:65], s14, v8
    v_lshrrev_b32 v9, 4, v192
    s_nop 0
    v_cndmask_b32 v200, 0, v200, s[64:65]
    v_cndmask_b32 v9, 0, v9, s[64:65]
    v_and_b32 v240, 0x7ff, v200
    ds_read_u8 v216, v9 offset:6144
    ds_read_u8 v224, v240 offset:4096
    v_bfe_u32 v232, v200, 11, 4
    s_cmp_lg_u32 s61, 1
    s_cbranch_scc1 K2_FA1
    v_mad_u32_u16 v27, v12, 32, v1 op_sel:[1,0,0,0]
    buffer_load_dwordx4 v[116:119], v27, s[36:39], 0 idxen
    buffer_load_dword v177, v27, s[48:51], 0 idxen
K2_FR1:
    v_add_u32 v8, 64, v19
    v_cmp_gt_u32 s[66:67], s14, v8
    v_lshrrev_b32 v9, 4, v193
    s_nop 0
    v_cndmask_b32 v202, 0, v202, s[66:67]
    v_cndmask_b32 v9, 0, v9, s[66:67]
    v_and_b32 v241, 0x7ff, v202
    ds_read_u8 v217, v9 offset:6144
    ds_read_u8 v225, v241 offset:4096
    v_bfe_u32 v233, v202, 11, 4
    s_cmp_lg_u32 s61, 1
    s_cbranch_scc1 K2_FA2
    v_mad_u32_u16 v26, v13, 32, v1 op_sel:[0,0,0,0]
    buffer_load_dwordx4 v[120:123], v26, s[36:39], 0 idxen
    buffer_load_dword v178, v26, s[48:51], 0 idxen
K2_FR2:
    v_add_u32 v8, 128, v19
    v_cmp_gt_u32 s[68:69], s14, v8
    v_lshrrev_b32 v9, 4, v194
    s_nop 0
    v_cndmask_b32 v204, 0, v204, s[68:69]
    v_cndmask_b32 v9, 0, v9, s[68:69]
    v_and_b32 v242, 0x7ff, v204
    ds_read_u8 v218, v9 offset:6144
    ds_read_u8 v226, v242 offset:4096
    v_bfe_u32 v234, v204, 11, 4
    s_cmp_lg_u32 s61, 1
    s_cbranch_scc1 K2_FA3
    v_mad_u32_u16 v27, v13, 32, v1 op_sel:[1,0,0,0]
    buffer_load_dwordx4 v[124:127], v27, s[36:39], 0 idxen
    buffer_load_dword v179, v27, s[48:51], 0 idxen
K2_FR3:
    v_add_u32 v8, 192, v19
    v_cmp_gt_u32 s[70:71], s14, v8
    v_lshrrev_b32 v9, 4, v195
    s_nop 0
    v_cndmask_b32 v206, 0, v206, s[70:71]
    v_cndmask_b32 v9, 0, v9, s[70:71]
    v_and_b32 v243, 0x7ff, v206
    ds_read_u8 v219, v9 offset:6144
    ds_read_u8 v227, v243 offset:4096
    v_bfe_u32 v235, v206, 11, 4
    s_cmp_lg_u32 s61, 1
    s_cbranch_scc1 K2_FA4
    v_mad_u32_u16 v26, v14, 32, v1 op_sel:[0,0,0,0]
    buffer_load_dwordx4 v[128:131], v26, s[36:39], 0 idxen
    buffer_load_dword v180, v26, s[48:51], 0 idxen
K2_FR4:
    s_cmp_le_u32 s52, 8
    s_cbranch_scc1 K2_R1C
    v_add_u32 v8, 256, v19
    v_cmp_gt_u32 s[72:73], s14, v8
    v_lshrrev_b32 v9, 4, v196
    s_nop 0
    v_cndmask_b32 v208, 0, v208, s[72:73]
    v_cndmask_b32 v9, 0, v9, s[72:73]
    v_and_b32 v244, 0x7ff, v208
    ds_read_u8 v220, v9 offset:6144
    ds_read_u8 v228, v244 offset:4096
    v_bfe_u32 v236, v208, 11, 4
    s_cmp_le_u32 s52, 10
    s_cbranch_scc1 K2_R1C
    v_add_u32 v8, 320, v19
    v_cmp_gt_u32 s[74:75], s14, v8
    v_lshrrev_b32 v9, 4, v197
    s_nop 0
    v_cndmask_b32 v210, 0, v210, s[74:75]
    v_cndmask_b32 v9, 0, v9, s[74:75]
    v_and_b32 v245, 0x7ff, v210
    ds_read_u8 v221, v9 offset:6144
    ds_read_u8 v229, v245 offset:4096
    v_bfe_u32 v237, v210, 11, 4
K2_R1C:
    s_waitcnt lgkmcnt(0)
    v_add_u32 v216, v216, v224
    v_lshl_add_u32 v224, v232, 2, s53
    s_mov_b64 exec, s[64:65]
    ds_max_u32 v224, v216 offset:1024
    s_mov_b64 exec, -1
    s_cmp_lg_u32 s61, 1
    s_cbranch_scc1 K2_FA5
    v_mad_u32_u16 v27, v14, 32, v1 op_sel:[1,0,0,0]
    buffer_load_dwordx4 v[132:135], v27, s[36:39], 0 idxen
    buffer_load_dword v181, v27, s[48:51], 0 idxen
K2_FR5:
    v_add_u32 v217, v217, v225
    v_lshl_add_u32 v225, v233, 2, s53
    s_mov_b64 exec, s[66:67]
    ds_max_u32 v225, v217 offset:1024
    s_mov_b64 exec, -1
    v_add_u32 v218, v218, v226
    v_lshl_add_u32 v226, v234, 2, s53
    s_mov_b64 exec, s[68:69]
    ds_max_u32 v226, v218 offset:1024
    s_mov_b64 exec, -1
    s_cmp_lg_u32 s61, 1
    s_cbranch_scc1 K2_FA6
    v_mad_u32_u16 v26, v15, 32, v1 op_sel:[0,0,0,0]
    buffer_load_dwordx4 v[136:139], v26, s[36:39], 0 idxen
    buffer_load_dword v182, v26, s[48:51], 0 idxen
K2_FR6:
    v_add_u32 v219, v219, v227
    v_lshl_add_u32 v227, v235, 2, s53
    s_mov_b64 exec, s[70:71]
    ds_max_u32 v227, v219 offset:1024
    s_mov_b64 exec, -1
    s_cmp_le_u32 s52, 8
    s_cbranch_scc1 K2_R1E
    v_add_u32 v220, v220, v228
    v_lshl_add_u32 v228, v236, 2, s53
    s_mov_b64 exec, s[72:73]
    ds_max_u32 v228, v220 offset:1024
    s_mov_b64 exec, -1
    s_cmp_le_u32 s52, 10
    s_cbranch_scc1 K2_R1E
    v_add_u32 v221, v221, v229
    v_lshl_add_u32 v229, v237, 2, s53
    s_mov_b64 exec, s[74:75]
    ds_max_u32 v229, v221 offset:1024
    s_mov_b64 exec, -1
K2_R1E:
    s_cmp_le_u32 s15, 12
    s_cbranch_scc1 K2_FIN
    v_add_u32 v16, 5376, v16
    v_add_u32 v17, 5376, v17
    v_add_u32 v18, 5376, v18
    v_add_u32 v19, 384, v19
    s_mov_b32 s61, 0
    s_sub_i32 s52, s52, 12
    s_cmp_gt_i32 s52, 0
    s_cbranch_scc1 K2_R1
    v_mul_u32_u24 v16, 28, v6
    v_add_u32 v16, s13, v16
    v_lshl_add_u32 v17, v1, 3, v16
    v_and_b32 v8, 0x130, v0
    v_bfe_u32 v9, v0, 6, 1
    v_lshl_or_b32 v8, v9, 7, v8
    v_bfe_u32 v9, v0, 7, 1
    v_lshl_or_b32 v8, v9, 6, v8
    v_lshrrev_b32 v8, 3, v8
    v_add_u32 v18, v16, v8
    v_lshrrev_b32 v8, 3, v0
    v_add_u32 v16, v16, v8
    v_lshrrev_b32 v19, 4, v7
    v_subrev_u32 v19, s57, v19
    s_mov_b32 s52, s15
    s_lshr_b32 s61, s57, 4
    s_add_u32 s61, s61, 1
K2_R2:
    ds_read_u16 v192, v16 offset:0
    ds_read_b64 v[200:201], v17 offset:64
    ds_read_u16 v193, v16 offset:896
    ds_read_b64 v[202:203], v17 offset:960
    ds_read_u16 v194, v16 offset:1792
    ds_read_b64 v[204:205], v17 offset:1856
    ds_read_u16 v195, v16 offset:2688
    ds_read_b64 v[206:207], v17 offset:2752
    s_cmp_le_u32 s52, 8
    s_cbranch_scc1 K2_R2A
    ds_read_u16 v196, v16 offset:3584
    ds_read_b64 v[208:209], v17 offset:3648
    s_cmp_le_u32 s52, 10
    s_cbranch_scc1 K2_R2A
    ds_read_u16 v197, v16 offset:4480
    ds_read_b64 v[210:211], v17 offset:4544
K2_R2A:
    s_waitcnt lgkmcnt(0)
    v_add_u32 v8, 0, v19
    v_cmp_gt_u32 s[64:65], s14, v8
    v_lshrrev_b32 v9, 4, v192
    s_nop 0
    v_cndmask_b32 v200, 0, v200, s[64:65]
    v_cndmask_b32 v9, 0, v9, s[64:65]
    v_and_b32 v240, 0x7ff, v200
    ds_read_u8 v216, v9 offset:6144
    ds_read_u8 v224, v240 offset:4096
    v_bfe_u32 v232, v200, 11, 4
    v_add_u32 v8, 64, v19
    v_cmp_gt_u32 s[66:67], s14, v8
    v_lshrrev_b32 v9, 4, v193
    s_nop 0
    v_cndmask_b32 v202, 0, v202, s[66:67]
    v_cndmask_b32 v9, 0, v9, s[66:67]
    v_and_b32 v241, 0x7ff, v202
    ds_read_u8 v217, v9 offset:6144
    ds_read_u8 v225, v241 offset:4096
    v_bfe_u32 v233, v202, 11, 4
    v_add_u32 v8, 128, v19
    v_cmp_gt_u32 s[68:69], s14, v8
    v_lshrrev_b32 v9, 4, v194
    s_nop 0
    v_cndmask_b32 v204, 0, v204, s[68:69]
    v_cndmask_b32 v9, 0, v9, s[68:69]
    v_and_b32 v242, 0x7ff, v204
    ds_read_u8 v218, v9 offset:6144
    ds_read_u8 v226, v242 offset:4096
    v_bfe_u32 v234, v204, 11, 4
    v_add_u32 v8, 192, v19
    v_cmp_gt_u32 s[70:71], s14, v8
    v_lshrrev_b32 v9, 4, v195
    s_nop 0
    v_cndmask_b32 v206, 0, v206, s[70:71]
    v_cndmask_b32 v9, 0, v9, s[70:71]
    v_and_b32 v243, 0x7ff, v206
    ds_read_u8 v219, v9 offset:6144
    ds_read_u8 v227, v243 offset:4096
    v_bfe_u32 v235, v206, 11, 4
    s_cmp_le_u32 s52, 8
    s_cbranch_scc1 K2_R2C
    v_add_u32 v8, 256, v19
    v_cmp_gt_u32 s[72:73], s14, v8
    v_lshrrev_b32 v9, 4, v196
    s_nop 0
    v_cndmask_b32 v208, 0, v208, s[72:73]
    v_cndmask_b32 v9, 0, v9, s[72:73]
    v_and_b32 v244, 0x7ff, v208
    ds_read_u8 v220, v9 offset:6144
    ds_read_u8 v228, v244 offset:4096
    v_bfe_u32 v236, v208, 11, 4
    s_cmp_le_u32 s52, 10
    s_cbranch_scc1 K2_R2C
    v_add_u32 v8, 320, v19
    v_cmp_gt_u32 s[74:75], s14, v8
    v_lshrrev_b32 v9, 4, v197
    s_nop 0
    v_cndmask_b32 v210, 0, v210, s[74:75]
    v_cndmask_b32 v9, 0, v9, s[74:75]
    v_and_b32 v245, 0x7ff, v210
    ds_read_u8 v221, v9 offset:6144
    ds_read_u8 v229, v245 offset:4096
    v_bfe_u32 v237, v210, 11, 4
K2_R2C:
    s_waitcnt lgkmcnt(0)
    v_add_u32 v216, v216, v224
    v_lshl_add_u32 v224, v232, 2, s53
    v_add_u32 v217, v217, v225
    v_lshl_add_u32 v225, v233, 2, s53
    v_add_u32 v218, v218, v226
    v_lshl_add_u32 v226, v234, 2, s53
    v_add_u32 v219, v219, v227
    v_lshl_add_u32 v227, v235, 2, s53
    s_cmp_le_u32 s52, 8
    s_cbranch_scc1 K2_R2E
    v_add_u32 v220, v220, v228
    v_lshl_add_u32 v228, v236, 2, s53
    s_cmp_le_u32 s52, 10
    s_cbranch_scc1 K2_R2E
    v_add_u32 v221, v221, v229
    v_lshl_add_u32 v229, v237, 2, s53
K2_R2E:
K2_FIN:
    ds_read_b32 v224, v224 offset:1024
    ds_read_b32 v225, v225 offset:1024
    ds_read_b32 v226, v226 offset:1024
    ds_read_b32 v227, v227 offset:1024
    s_cmp_le_u32 s52, 8
    s_cbranch_scc1 K2_F1
    ds_read_b32 v228, v228 offset:1024
    s_cmp_le_u32 s52, 10
    s_cbranch_scc1 K2_F1
    ds_read_b32 v229, v229 offset:1024
K2_F1:
    s_cmp_lg_u32 s61, 1
    s_cbranch_scc1 K2_FA7
    v_mad_u32_u16 v27, v15, 32, v1 op_sel:[1,0,0,0]
    buffer_load_dwordx4 v[140:143], v27, s[36:39], 0 idxen
    buffer_load_dword v183, v27, s[48:51], 0 idxen
K2_FR7:
    s_waitcnt lgkmcnt(0)
    s_cmp_gt_u32 s52, 1
    s_cselect_b32 exec_hi, -1, 0
    v_cndmask_b32 v20, -1, v192, s[64:65]
    v_lshlrev_b32 v21, v232, 1
    v_lshlrev_b32 v240, 5, v240
    v_cndmask_b32 v21, 0, v21, s[64:65]
    ds_write_b16 v16, v20 offset:0
    ds_write_b16 v18, v240 offset:64
    ds_write_b16 v18, v21 offset:128
    v_sub_u32 v216, v216, v224
    v_add_u32 v216, 14, v216
    v_and_b32 v22, s4, v200
    v_lshlrev_b32 v23, 16, v201
    v_and_b32 v24, s4, v201
    v_ldexp_f32 v25, 1.0, v216
    v_ldexp_f32 v22, v22, v216
    v_ldexp_f32 v23, v23, v216
    v_ldexp_f32 v24, v24, v216
    v_cvt_pk_f16_f32 v25, v25, v22
    v_cvt_pk_f16_f32 v23, v23, v24
    ds_write_b16 v18, v25 offset:192
    ds_write_b16_d16_hi v18, v25 offset:256
    ds_write_b16 v18, v23 offset:320
    ds_write_b16_d16_hi v18, v23 offset:384
    s_mov_b64 exec, -1
    s_cmp_gt_u32 s52, 3
    s_cselect_b32 exec_hi, -1, 0
    s_cmp_gt_u32 s52, 2
    s_cselect_b32 exec_lo, -1, 0
    v_cndmask_b32 v20, -1, v193, s[66:67]
    v_lshlrev_b32 v21, v233, 1
    v_lshlrev_b32 v241, 5, v241
    v_cndmask_b32 v21, 0, v21, s[66:67]
    ds_write_b16 v16, v20 offset:896
    ds_write_b16 v18, v241 offset:960
    ds_write_b16 v18, v21 offset:1024
    v_sub_u32 v217, v217, v225
    v_add_u32 v217, 14, v217
    v_and_b32 v22, s4, v202
    v_lshlrev_b32 v23, 16, v203
    v_and_b32 v24, s4, v203
    v_ldexp_f32 v25, 1.0, v217
    v_ldexp_f32 v22, v22, v217
    v_ldexp_f32 v23, v23, v217
    v_ldexp_f32 v24, v24, v217
    v_cvt_pk_f16_f32 v25, v25, v22
    v_cvt_pk_f16_f32 v23, v23, v24
    ds_write_b16 v18, v25 offset:1088
    ds_write_b16_d16_hi v18, v25 offset:1152
    ds_write_b16 v18, v23 offset:1216
    ds_write_b16_d16_hi v18, v23 offset:1280
    s_mov_b64 exec, -1
    s_cmp_gt_u32 s52, 5
    s_cselect_b32 exec_hi, -1, 0
    s_cmp_gt_u32 s52, 4
    s_cselect_b32 exec_lo, -1, 0
    v_cndmask_b32 v20, -1, v194, s[68:69]
    v_lshlrev_b32 v21, v234, 1
    v_lshlrev_b32 v242, 5, v242
    v_cndmask_b32 v21, 0, v21, s[68:69]
    ds_write_b16 v16, v20 offset:1792
    ds_write_b16 v18, v242 offset:1856
    ds_write_b16 v18, v21 offset:1920
    v_sub_u32 v218, v218, v226
    v_add_u32 v218, 14, v218
    v_and_b32 v22, s4, v204
    v_lshlrev_b32 v23, 16, v205
    v_and_b32 v24, s4, v205
    v_ldexp_f32 v25, 1.0, v218
    v_ldexp_f32 v22, v22, v218
    v_ldexp_f32 v23, v23, v218
    v_ldexp_f32 v24, v24, v218
    v_cvt_pk_f16_f32 v25, v25, v22
    v_cvt_pk_f16_f32 v23, v23, v24
    ds_write_b16 v18, v25 offset:1984
    ds_write_b16_d16_hi v18, v25 offset:2048
    ds_write_b16 v18, v23 offset:2112
    ds_write_b16_d16_hi v18, v23 offset:2176
    s_mov_b64 exec, -1
    s_cmp_gt_u32 s52, 7
    s_cselect_b32 exec_hi, -1, 0
    s_cmp_gt_u32 s52, 6
    s_cselect_b32 exec_lo, -1, 0
    v_cndmask_b32 v20, -1, v195, s[70:71]
    v_lshlrev_b32 v21, v235, 1
    v_lshlrev_b32 v243, 5, v243
    v_cndmask_b32 v21, 0, v21, s[70:71]
    ds_write_b16 v16, v20 offset:2688
    ds_write_b16 v18, v243 offset:2752
    ds_write_b16 v18, v21 offset:2816
    v_sub_u32 v219, v219, v227
    v_add_u32 v219, 14, v219
    v_and_b32 v22, s4, v206
    v_lshlrev_b32 v23, 16, v207
    v_and_b32 v24, s4, v207
    v_ldexp_f32 v25, 1.0, v219
    v_ldexp_f32 v22, v22, v219
    v_ldexp_f32 v23, v23, v219
    v_ldexp_f32 v24, v24, v219
    v_cvt_pk_f16_f32 v25, v25, v22
    v_cvt_pk_f16_f32 v23, v23, v24
    ds_write_b16 v18, v25 offset:2880
    ds_write_b16_d16_hi v18, v25 offset:2944
    ds_write_b16 v18, v23 offset:3008
    ds_write_b16_d16_hi v18, v23 offset:3072
    s_mov_b64 exec, -1
    s_cmp_le_u32 s52, 8
    s_cbranch_scc1 K2_F2
    s_cmp_gt_u32 s52, 9
    s_cselect_b32 exec_hi, -1, 0
    v_cndmask_b32 v20, -1, v196, s[72:73]
    v_lshlrev_b32 v21, v236, 1
    v_lshlrev_b32 v244, 5, v244
    v_cndmask_b32 v21, 0, v21, s[72:73]
    ds_write_b16 v16, v20 offset:3584
    ds_write_b16 v18, v244 offset:3648
    ds_write_b16 v18, v21 offset:3712
    v_sub_u32 v220, v220, v228
    v_add_u32 v220, 14, v220
    v_and_b32 v22, s4, v208
    v_lshlrev_b32 v23, 16, v209
    v_and_b32 v24, s4, v209
    v_ldexp_f32 v25, 1.0, v220
    v_ldexp_f32 v22, v22, v220
    v_ldexp_f32 v23, v23, v220
    v_ldexp_f32 v24, v24, v220
    v_cvt_pk_f16_f32 v25, v25, v22
    v_cvt_pk_f16_f32 v23, v23, v24
    ds_write_b16 v18, v25 offset:3776
    ds_write_b16_d16_hi v18, v25 offset:3840
    ds_write_b16 v18, v23 offset:3904
    ds_write_b16_d16_hi v18, v23 offset:3968
    s_mov_b64 exec, -1
    s_cmp_le_u32 s52, 10
    s_cbranch_scc1 K2_F2
    s_cmp_gt_u32 s52, 11
    s_cselect_b32 exec_hi, -1, 0
    v_cndmask_b32 v20, -1, v197, s[74:75]
    v_lshlrev_b32 v21, v237, 1
    v_lshlrev_b32 v245, 5, v245
    v_cndmask_b32 v21, 0, v21, s[74:75]
    ds_write_b16 v16, v20 offset:4480
    ds_write_b16 v18, v245 offset:4544
    ds_write_b16 v18, v21 offset:4608
    v_sub_u32 v221, v221, v229
    v_add_u32 v221, 14, v221
    v_and_b32 v22, s4, v210
    v_lshlrev_b32 v23, 16, v211
    v_and_b32 v24, s4, v211
    v_ldexp_f32 v25, 1.0, v221
    v_ldexp_f32 v22, v22, v221
    v_ldexp_f32 v23, v23, v221
    v_ldexp_f32 v24, v24, v221
    v_cvt_pk_f16_f32 v25, v25, v22
    v_cvt_pk_f16_f32 v23, v23, v24
    ds_write_b16 v18, v25 offset:4672
    ds_write_b16_d16_hi v18, v25 offset:4736
    ds_write_b16 v18, v23 offset:4800
    ds_write_b16_d16_hi v18, v23 offset:4864
    s_mov_b64 exec, -1
K2_F2:
    s_mov_b32 s61, 0
    v_add_u32 v16, 5376, v16
    v_add_u32 v17, 5376, v17
    v_add_u32 v18, 5376, v18
    v_add_u32 v19, 384, v19
    s_sub_i32 s52, s52, 12
    s_cmp_gt_i32 s52, 0
    s_cbranch_scc1 K2_R2
    ds_read_u16 v10, v5 offset:64
    s_waitcnt lgkmcnt(0)
    v_and_or_b32 v10, v10, s54, v6
    ds_read_b128 v[16:19], v10 offset:13888
    ds_read_b128 v[20:23], v7 offset:11840
    ds_read_b128 v[24:27], v7 offset:12864
    ds_read_b128 v[12:15], v4 offset:32
    ds_read_b128 v[28:31], v4 offset:128
    ds_read_b128 v[36:39], v4 offset:256
    ds_read_b128 v[40:43], v4 offset:320
    ds_read_b128 v[44:47], v4 offset:384
    ds_read_b128 v[32:35], v4 offset:192
    s_mov_b32 s52, 1
    s_cmp_lg_u32 s57, 0
    s_cselect_b64 vcc, -1, 0
    s_mov_b32 s61, 0
K2_LOOP:
    s_cmp_eq_u32 s52, s61
    s_cselect_b32 s60, s52, s15
    ds_read_u16 v10, v5 offset:512
    s_waitcnt lgkmcnt(7)
    v_mfma_f32_32x32x16_bf16 v[192:207], v[16:19], v[20:23], 0
    v_mfma_f32_32x32x16_bf16 v[240:255], v[16:19], v[24:27], 0
    ds_read_b128 v[20:23], v7 offset:7744
    ds_read_b128 v[24:27], v7 offset:8768
    s_waitcnt lgkmcnt(8)
    s_cbranch_vccnz K2_PEND0
    v_mad_u32_u16 v8, v12, 32, v1 op_sel:[0,0,0,0]
    buffer_load_dwordx4 v[144:147], v8, s[36:39], 0 idxen
    buffer_load_dword v184, v8, s[48:51], 0 idxen
    v_mad_u32_u16 v9, v12, 32, v1 op_sel:[1,0,0,0]
    buffer_load_dwordx4 v[148:151], v9, s[36:39], 0 idxen
    buffer_load_dword v185, v9, s[48:51], 0 idxen
K2_PEND0:
    s_waitcnt lgkmcnt(3)
    v_pk_lshlrev_b16 v28, v2, v28
    v_pk_lshlrev_b16 v29, v2, v29
    v_pk_lshlrev_b16 v30, v2, v30
    v_pk_lshlrev_b16 v31, v2, v31
    v_pk_ashrrev_i16 v28, 15, v28 op_sel_hi:[0,1]
    v_pk_ashrrev_i16 v29, 15, v29 op_sel_hi:[0,1]
    v_pk_ashrrev_i16 v30, 15, v30 op_sel_hi:[0,1]
    v_pk_ashrrev_i16 v31, 15, v31 op_sel_hi:[0,1]
    v_and_b32 v36, v36, v28
    v_and_b32 v37, v37, v29
    v_and_b32 v38, v38, v30
    v_and_b32 v39, v39, v31
    v_and_b32 v40, v40, v28
    v_and_b32 v41, v41, v29
    v_and_b32 v42, v42, v30
    v_and_b32 v43, v43, v31
    v_and_b32 v44, v44, v28
    v_and_b32 v45, v45, v29
    v_and_b32 v46, v46, v30
    v_and_b32 v47, v47, v31
    v_and_b32 v32, v32, v28
    v_and_b32 v33, v33, v29
    v_and_b32 v34, v34, v30
    v_and_b32 v35, v35, v31
    s_waitcnt lgkmcnt(0)
    v_mfma_f32_32x32x16_bf16 v[208:223], v[16:19], v[20:23], 0
    v_mfma_f32_32x32x16_bf16 v[224:239], v[16:19], v[24:27], 0
    ds_read_b128 v[20:23], v7 offset:10816
    ds_read_b128 v[24:27], v7 offset:9792
    s_cbranch_vccnz K2_PEND1
    v_mad_u32_u16 v8, v13, 32, v1 op_sel:[0,0,0,0]
    buffer_load_dwordx4 v[152:155], v8, s[36:39], 0 idxen
    buffer_load_dword v186, v8, s[48:51], 0 idxen
    v_mad_u32_u16 v9, v13, 32, v1 op_sel:[1,0,0,0]
    buffer_load_dwordx4 v[156:159], v9, s[36:39], 0 idxen
    buffer_load_dword v187, v9, s[48:51], 0 idxen
K2_PEND1:
    v_cvt_pk_f16_f32 v192, v192, v240
    v_cvt_pk_f16_f32 v193, v193, v241
    v_cvt_pk_f16_f32 v194, v194, v242
    v_cvt_pk_f16_f32 v195, v195, v243
    v_cvt_pk_f16_f32 v196, v196, v244
    v_cvt_pk_f16_f32 v197, v197, v245
    v_cvt_pk_f16_f32 v198, v198, v246
    v_cvt_pk_f16_f32 v199, v199, v247
    v_cvt_pk_f16_f32 v200, v200, v248
    v_cvt_pk_f16_f32 v201, v201, v249
    v_cvt_pk_f16_f32 v202, v202, v250
    v_cvt_pk_f16_f32 v203, v203, v251
    v_cvt_pk_f16_f32 v204, v204, v252
    v_cvt_pk_f16_f32 v205, v205, v253
    v_cvt_pk_f16_f32 v206, v206, v254
    v_cvt_pk_f16_f32 v207, v207, v255
    s_waitcnt lgkmcnt(1)
    v_mfma_f32_32x32x16_bf16 v[240:255], v[16:19], v[20:23], 0
    v_cvt_pk_f16_f32 v208, v208, v224
    v_cvt_pk_f16_f32 v209, v209, v225
    v_cvt_pk_f16_f32 v210, v210, v226
    v_cvt_pk_f16_f32 v211, v211, v227
    v_cvt_pk_f16_f32 v212, v212, v228
    v_cvt_pk_f16_f32 v213, v213, v229
    v_cvt_pk_f16_f32 v214, v214, v230
    v_cvt_pk_f16_f32 v215, v215, v231
    s_cbranch_vccnz K2_PEND2
    v_mad_u32_u16 v8, v14, 32, v1 op_sel:[0,0,0,0]
    buffer_load_dwordx4 v[160:163], v8, s[36:39], 0 idxen
    buffer_load_dword v188, v8, s[48:51], 0 idxen
    v_mad_u32_u16 v9, v14, 32, v1 op_sel:[1,0,0,0]
    buffer_load_dwordx4 v[164:167], v9, s[36:39], 0 idxen
    buffer_load_dword v189, v9, s[48:51], 0 idxen
K2_PEND2:
    v_cvt_pk_f16_f32 v216, v216, v232
    v_cvt_pk_f16_f32 v217, v217, v233
    v_cvt_pk_f16_f32 v218, v218, v234
    v_cvt_pk_f16_f32 v219, v219, v235
    v_cvt_pk_f16_f32 v220, v220, v236
    v_cvt_pk_f16_f32 v221, v221, v237
    v_cvt_pk_f16_f32 v222, v222, v238
    v_cvt_pk_f16_f32 v223, v223, v239
    s_waitcnt lgkmcnt(0)
    v_mfma_f32_32x32x16_bf16 v[224:239], v[16:19], v[24:27], 0
    v_and_or_b32 v10, v10, s54, v6
    ds_read_b128 v[16:19], v10 offset:13888
    ds_read_b128 v[20:23], v7 offset:11840
    ds_read_b128 v[24:27], v7 offset:12864
    s_cbranch_vccnz K2_HALF
K2_NOHALF:
    s_waitcnt vmcnt(12)
    v_pk_mul_f16 v192, v192, v176
    v_pk_mul_f16 v193, v193, v177
    v_pk_mul_f16 v194, v194, v178
    v_pk_mul_f16 v195, v195, v179
    v_pk_mul_f16 v196, v196, v180
    v_pk_mul_f16 v197, v197, v181
    v_pk_mul_f16 v198, v198, v182
    v_pk_mul_f16 v199, v199, v183
    v_pk_mul_f16 v208, v208, v112
    v_pk_mul_f16 v209, v209, v116
    v_smfmac_f32_32x32x32_f16 v[64:79], v[36:39], v[192:199], v3
    v_pk_mul_f16 v210, v210, v120
    v_pk_mul_f16 v211, v211, v124
    v_pk_mul_f16 v212, v212, v128
    v_pk_mul_f16 v213, v213, v132
    v_pk_mul_f16 v214, v214, v136
    v_pk_mul_f16 v215, v215, v140
    v_smfmac_f32_32x32x32_f16 v[80:95], v[40:43], v[192:199], v3
    v_cvt_pk_f16_f32 v224, v224, v240
    v_cvt_pk_f16_f32 v225, v225, v241
    v_cvt_pk_f16_f32 v226, v226, v242
    v_cvt_pk_f16_f32 v227, v227, v243
    v_cvt_pk_f16_f32 v228, v228, v244
    v_cvt_pk_f16_f32 v229, v229, v245
    v_smfmac_f32_32x32x32_f16 v[96:111], v[44:47], v[192:199], v3
    s_cbranch_vccnz K2_PEND3
    v_mad_u32_u16 v8, v15, 32, v1 op_sel:[0,0,0,0]
    buffer_load_dwordx4 v[168:171], v8, s[36:39], 0 idxen
    buffer_load_dword v190, v8, s[48:51], 0 idxen
    v_mad_u32_u16 v9, v15, 32, v1 op_sel:[1,0,0,0]
    buffer_load_dwordx4 v[172:175], v9, s[36:39], 0 idxen
    buffer_load_dword v191, v9, s[48:51], 0 idxen
K2_PEND3:
    ds_read_b128 v[12:15], v4 offset:448
    ds_read_b128 v[28:31], v4 offset:160
    ds_read_b128 v[36:39], v4 offset:288
    ds_read_b128 v[40:43], v4 offset:352
    ds_read_b128 v[44:47], v4 offset:416
    v_cvt_pk_f16_f32 v230, v230, v246
    v_cvt_pk_f16_f32 v231, v231, v247
    v_cvt_pk_f16_f32 v232, v232, v248
    v_cvt_pk_f16_f32 v233, v233, v249
    v_cvt_pk_f16_f32 v234, v234, v250
    v_cvt_pk_f16_f32 v235, v235, v251
    v_smfmac_f32_32x32x32_f16 v[48:63], v[32:35], v[208:215], v3
    v_cvt_pk_f16_f32 v236, v236, v252
    v_cvt_pk_f16_f32 v237, v237, v253
    v_cvt_pk_f16_f32 v238, v238, v254
    v_cvt_pk_f16_f32 v239, v239, v255
    v_pk_mul_f16 v240, v224, v113
    v_pk_mul_f16 v241, v225, v117
    v_pk_mul_f16 v242, v226, v121
    v_pk_mul_f16 v243, v227, v125
    v_pk_mul_f16 v244, v228, v129
    v_pk_mul_f16 v245, v229, v133
    v_pk_mul_f16 v246, v230, v137
    v_pk_mul_f16 v247, v231, v141
    v_pk_mul_f16 v248, v224, v114
    v_pk_mul_f16 v249, v225, v118
    v_smfmac_f32_32x32x32_f16 v[64:79], v[32:35], v[240:247], v3
    v_pk_mul_f16 v250, v226, v122
    v_pk_mul_f16 v251, v227, v126
    v_pk_mul_f16 v252, v228, v130
    v_pk_mul_f16 v253, v229, v134
    v_pk_mul_f16 v254, v230, v138
    v_pk_mul_f16 v255, v231, v142
    v_pk_mul_f16 v224, v224, v115
    v_pk_mul_f16 v225, v225, v119
    v_smfmac_f32_32x32x32_f16 v[80:95], v[32:35], v[248:255], v3
    v_pk_mul_f16 v226, v226, v123
    v_pk_mul_f16 v227, v227, v127
    v_pk_mul_f16 v228, v228, v131
    v_pk_mul_f16 v229, v229, v135
    v_pk_mul_f16 v230, v230, v139
    v_pk_mul_f16 v231, v231, v143
    s_waitcnt lgkmcnt(3)
    v_pk_lshlrev_b16 v28, v2, v28
    v_pk_lshlrev_b16 v29, v2, v29
    v_smfmac_f32_32x32x32_f16 v[96:111], v[32:35], v[224:231], v3
    ds_read_b128 v[32:35], v4 offset:224
K2_HRET:
    s_mov_b64 vcc, 0
    s_cmp_eq_u32 s52, s60
    s_cbranch_scc1 K2_RET0
    v_mad_u32_u16 v8, v12, 32, v1 op_sel:[0,0,0,0]
    buffer_load_dwordx4 v[112:115], v8, s[36:39], 0 idxen
    buffer_load_dword v176, v8, s[48:51], 0 idxen
    v_mad_u32_u16 v9, v12, 32, v1 op_sel:[1,0,0,0]
    buffer_load_dwordx4 v[116:119], v9, s[36:39], 0 idxen
    buffer_load_dword v177, v9, s[48:51], 0 idxen
K2_RET0:
    v_pk_lshlrev_b16 v30, v2, v30
    v_pk_lshlrev_b16 v31, v2, v31
    v_pk_ashrrev_i16 v28, 15, v28 op_sel_hi:[0,1]
    v_pk_ashrrev_i16 v29, 15, v29 op_sel_hi:[0,1]
    v_pk_ashrrev_i16 v30, 15, v30 op_sel_hi:[0,1]
    v_pk_ashrrev_i16 v31, 15, v31 op_sel_hi:[0,1]
    s_waitcnt lgkmcnt(1)
    v_and_b32 v36, v36, v28
    v_and_b32 v37, v37, v29
    v_and_b32 v38, v38, v30
    v_and_b32 v39, v39, v31
    v_and_b32 v40, v40, v28
    v_and_b32 v41, v41, v29
    v_and_b32 v42, v42, v30
    v_and_b32 v43, v43, v31
    v_and_b32 v44, v44, v28
    v_and_b32 v45, v45, v29
    v_and_b32 v46, v46, v30
    v_and_b32 v47, v47, v31
    s_cmp_eq_u32 s52, s60
    s_cbranch_scc1 K2_RET1
    v_mad_u32_u16 v8, v13, 32, v1 op_sel:[0,0,0,0]
    buffer_load_dwordx4 v[120:123], v8, s[36:39], 0 idxen
    buffer_load_dword v178, v8, s[48:51], 0 idxen
    v_mad_u32_u16 v9, v13, 32, v1 op_sel:[1,0,0,0]
    buffer_load_dwordx4 v[124:127], v9, s[36:39], 0 idxen
    buffer_load_dword v179, v9, s[48:51], 0 idxen
K2_RET1:
    s_cmp_eq_u32 s52, s15
    s_cbranch_scc0 K2_WLAST
    s_waitcnt vmcnt(0)
K2_WLAST:
    s_waitcnt vmcnt(8)
    v_pk_mul_f16 v200, v200, v184
    v_pk_mul_f16 v201, v201, v185
    v_pk_mul_f16 v202, v202, v186
    v_pk_mul_f16 v203, v203, v187
    v_pk_mul_f16 v204, v204, v188
    v_pk_mul_f16 v205, v205, v189
    v_pk_mul_f16 v206, v206, v190
    v_pk_mul_f16 v207, v207, v191
    s_waitcnt lgkmcnt(0)
    v_and_b32 v32, v32, v28
    v_and_b32 v33, v33, v29
    v_and_b32 v34, v34, v30
    v_and_b32 v35, v35, v31
    v_smfmac_f32_32x32x32_f16 v[64:79], v[36:39], v[200:207], v3
    v_pk_mul_f16 v216, v216, v144
    v_pk_mul_f16 v217, v217, v148
    v_pk_mul_f16 v218, v218, v152
    v_pk_mul_f16 v219, v219, v156
    v_pk_mul_f16 v220, v220, v160
    v_pk_mul_f16 v221, v221, v164
    v_pk_mul_f16 v222, v222, v168
    v_pk_mul_f16 v223, v223, v172
    v_smfmac_f32_32x32x32_f16 v[80:95], v[40:43], v[200:207], v3
    s_cmp_eq_u32 s52, s60
    s_cbranch_scc1 K2_RET2
    v_mad_u32_u16 v8, v14, 32, v1 op_sel:[0,0,0,0]
    buffer_load_dwordx4 v[128:131], v8, s[36:39], 0 idxen
    buffer_load_dword v180, v8, s[48:51], 0 idxen
    v_mad_u32_u16 v9, v14, 32, v1 op_sel:[1,0,0,0]
    buffer_load_dwordx4 v[132:135], v9, s[36:39], 0 idxen
    buffer_load_dword v181, v9, s[48:51], 0 idxen
K2_RET2:
    v_pk_mul_f16 v240, v232, v145
    v_pk_mul_f16 v241, v233, v149
    v_pk_mul_f16 v242, v234, v153
    v_pk_mul_f16 v243, v235, v157
    v_smfmac_f32_32x32x32_f16 v[96:111], v[44:47], v[200:207], v3
    v_pk_mul_f16 v244, v236, v161
    v_pk_mul_f16 v245, v237, v165
    v_pk_mul_f16 v246, v238, v169
    v_pk_mul_f16 v247, v239, v173
    v_pk_mul_f16 v248, v232, v146
    v_pk_mul_f16 v249, v233, v150
    v_smfmac_f32_32x32x32_f16 v[48:63], v[32:35], v[216:223], v3
    v_pk_mul_f16 v250, v234, v154
    v_pk_mul_f16 v251, v235, v158
    v_pk_mul_f16 v252, v236, v162
    v_pk_mul_f16 v253, v237, v166
    v_pk_mul_f16 v254, v238, v170
    v_pk_mul_f16 v255, v239, v174
    v_smfmac_f32_32x32x32_f16 v[64:79], v[32:35], v[240:247], v3
    s_cmp_eq_u32 s52, s60
    s_cbranch_scc1 K2_RET3
    v_mad_u32_u16 v8, v15, 32, v1 op_sel:[0,0,0,0]
    buffer_load_dwordx4 v[136:139], v8, s[36:39], 0 idxen
    buffer_load_dword v182, v8, s[48:51], 0 idxen
    v_mad_u32_u16 v9, v15, 32, v1 op_sel:[1,0,0,0]
    buffer_load_dwordx4 v[140:143], v9, s[36:39], 0 idxen
    buffer_load_dword v183, v9, s[48:51], 0 idxen
K2_RET3:
    v_add_u32 v4, 448, v4
    ds_read_b128 v[12:15], v4 offset:32
    ds_read_b128 v[28:31], v4 offset:128
    ds_read_b128 v[36:39], v4 offset:256
    ds_read_b128 v[40:43], v4 offset:320
    ds_read_b128 v[44:47], v4 offset:384
    v_pk_mul_f16 v232, v232, v147
    v_pk_mul_f16 v233, v233, v151
    v_pk_mul_f16 v234, v234, v155
    v_pk_mul_f16 v235, v235, v159
    v_smfmac_f32_32x32x32_f16 v[80:95], v[32:35], v[248:255], v3
    v_pk_mul_f16 v236, v236, v163
    v_pk_mul_f16 v237, v237, v167
    v_pk_mul_f16 v238, v238, v171
    v_pk_mul_f16 v239, v239, v175
    v_add_u32 v5, 448, v5
    s_cmp_gt_u32 s52, s22
    v_smfmac_f32_32x32x32_f16 v[96:111], v[32:35], v[232:239], v3
    ds_read_b128 v[32:35], v4 offset:192
    s_cbranch_scc1 K2_NOBAR
    s_barrier
K2_NOBAR:
    s_add_u32 s52, s52, 1
    s_cmp_le_u32 s52, s15
    s_cbranch_scc1 K2_LOOP
    s_waitcnt lgkmcnt(0)
    s_lshl_b32 s6, s3, 2
    s_sub_u32 s7, 28, s6
    v_lshl_add_u32 v8, v6, 2, s6
    v_lshl_add_u32 v9, v6, 2, s7
    ds_read_b32 v208, v8 offset:3584
    ds_read_b32 v209, v9 offset:3616
    ds_read_b32 v210, v8 offset:3712
    ds_read_b32 v211, v9 offset:3744
    ds_read_b32 v212, v8 offset:3840
    ds_read_b32 v213, v9 offset:3872
    ds_read_b32 v214, v8 offset:3968
    v_lshrrev_b32 v10, 1, v6
    v_add_u32 v10, s53, v10
    ds_read_b32 v192, v10 offset:1024
    ds_read_b32 v193, v10 offset:1028
    ds_read_b32 v194, v10 offset:1040
    ds_read_b32 v195, v10 offset:1044
    ds_read_b32 v196, v10 offset:1056
    ds_read_b32 v197, v10 offset:1060
    ds_read_b32 v198, v10 offset:1072
    v_add_u32 v11, 113664, v11
    s_waitcnt lgkmcnt(7)
    v_add_u32 v200, v208, v11
    v_add_u32 v201, v209, v11
    v_add_u32 v202, v210, v11
    v_add_u32 v203, v211, v11
    v_add_u32 v204, v212, v11
    v_add_u32 v205, v213, v11
    v_add_u32 v206, v214, v11
    s_waitcnt lgkmcnt(0)
    ds_read2_b32 v[112:113], v200 offset0:0 offset1:32
    ds_read2_b32 v[114:115], v200 offset0:64 offset1:96
    ds_read2_b32 v[116:117], v201 offset0:0 offset1:32
    ds_read2_b32 v[118:119], v201 offset0:64 offset1:96
    ds_read2_b32 v[120:121], v202 offset0:0 offset1:32
    ds_read2_b32 v[122:123], v202 offset0:64 offset1:96
    ds_read2_b32 v[124:125], v203 offset0:0 offset1:32
    ds_read2_b32 v[126:127], v203 offset0:64 offset1:96
    ds_read2_b32 v[128:129], v204 offset0:0 offset1:32
    ds_read2_b32 v[130:131], v204 offset0:64 offset1:96
    ds_read2_b32 v[132:133], v205 offset0:0 offset1:32
    ds_read2_b32 v[134:135], v205 offset0:64 offset1:96
    ds_read2_b32 v[136:137], v206 offset0:0 offset1:32
    ds_read2_b32 v[138:139], v206 offset0:64 offset1:96
    v_subrev_u32 v192, 281, v192
    v_add_u32 v208, v208, v0
    v_subrev_u32 v193, 281, v193
    v_add_u32 v209, v209, v0
    v_subrev_u32 v194, 281, v194
    v_add_u32 v210, v210, v0
    v_subrev_u32 v195, 281, v195
    v_add_u32 v211, v211, v0
    v_subrev_u32 v196, 281, v196
    v_add_u32 v212, v212, v0
    v_subrev_u32 v197, 281, v197
    v_add_u32 v213, v213, v0
    v_subrev_u32 v198, 281, v198
    v_add_u32 v214, v214, v0
    v_mov_b32 v226, 0
    v_cmp_ne_u32 vcc, -281, v192
    s_nop 1
    v_cndmask_b32 v192, 0, v192, vcc
    v_add_u32 v227, 126, v192
    v_max_u32 v226, v226, v227
    v_cmp_ne_u32 vcc, -281, v193
    s_nop 1
    v_cndmask_b32 v193, 0, v193, vcc
    v_add_u32 v227, 126, v193
    v_max_u32 v226, v226, v227
    v_cmp_ne_u32 vcc, -281, v194
    s_nop 1
    v_cndmask_b32 v194, 0, v194, vcc
    v_add_u32 v227, 126, v194
    v_max_u32 v226, v226, v227
    v_cmp_ne_u32 vcc, -281, v195
    s_nop 1
    v_cndmask_b32 v195, 0, v195, vcc
    v_add_u32 v227, 126, v195
    v_max_u32 v226, v226, v227
    v_cmp_ne_u32 vcc, -281, v196
    s_nop 1
    v_cndmask_b32 v196, 0, v196, vcc
    v_add_u32 v227, 126, v196
    v_max_u32 v226, v226, v227
    v_cmp_ne_u32 vcc, -281, v197
    s_nop 1
    v_cndmask_b32 v197, 0, v197, vcc
    v_add_u32 v227, 126, v197
    v_max_u32 v226, v226, v227
    v_cmp_ne_u32 vcc, -281, v198
    s_nop 1
    v_cndmask_b32 v198, 0, v198, vcc
    v_add_u32 v227, 126, v198
    v_max_u32 v226, v226, v227
    v_cmp_lt_u32 vcc, 253, v226
    s_cbranch_vccnz K2_ESLOW
K2_EBACK:
    v_ldexp_f32 v192, 1.0, v192
    v_ldexp_f32 v193, 1.0, v193
    v_ldexp_f32 v194, 1.0, v194
    v_ldexp_f32 v195, 1.0, v195
    v_ldexp_f32 v196, 1.0, v196
    v_ldexp_f32 v197, 1.0, v197
    v_ldexp_f32 v198, 1.0, v198
    s_waitcnt lgkmcnt(0)
    v_lshlrev_b32 v224, 16, v112
    v_and_b32 v225, s4, v112
    v_fma_f32 v48, v48, v192, v224
    v_fma_f32 v49, v49, v192, v225
    v_cvt_pk_bf16_f32 v112, v48, v49
    v_lshlrev_b32 v224, 16, v113
    v_and_b32 v225, s4, v113
    v_fma_f32 v64, v64, v192, v224
    v_fma_f32 v65, v65, v192, v225
    v_cvt_pk_bf16_f32 v113, v64, v65
    v_lshlrev_b32 v224, 16, v114
    v_and_b32 v225, s4, v114
    v_fma_f32 v80, v80, v192, v224
    v_fma_f32 v81, v81, v192, v225
    v_cvt_pk_bf16_f32 v114, v80, v81
    v_lshlrev_b32 v224, 16, v115
    v_and_b32 v225, s4, v115
    v_fma_f32 v96, v96, v192, v224
    v_fma_f32 v97, v97, v192, v225
    v_cvt_pk_bf16_f32 v115, v96, v97
    ds_write2_b32 v200, v112, v113 offset0:0 offset1:32
    ds_write2_b32 v200, v114, v115 offset0:64 offset1:96
    v_add_u32 v8, 113664, v208
    ds_read_b128 v[144:147], v8
    v_lshlrev_b32 v224, 16, v116
    v_and_b32 v225, s4, v116
    v_fma_f32 v50, v50, v193, v224
    v_fma_f32 v51, v51, v193, v225
    v_cvt_pk_bf16_f32 v116, v50, v51
    v_lshlrev_b32 v224, 16, v117
    v_and_b32 v225, s4, v117
    v_fma_f32 v66, v66, v193, v224
    v_fma_f32 v67, v67, v193, v225
    v_cvt_pk_bf16_f32 v117, v66, v67
    v_lshlrev_b32 v224, 16, v118
    v_and_b32 v225, s4, v118
    v_fma_f32 v82, v82, v193, v224
    v_fma_f32 v83, v83, v193, v225
    v_cvt_pk_bf16_f32 v118, v82, v83
    v_lshlrev_b32 v224, 16, v119
    v_and_b32 v225, s4, v119
    v_fma_f32 v98, v98, v193, v224
    v_fma_f32 v99, v99, v193, v225
    v_cvt_pk_bf16_f32 v119, v98, v99
    ds_write2_b32 v201, v116, v117 offset0:0 offset1:32
    ds_write2_b32 v201, v118, v119 offset0:64 offset1:96
    v_add_u32 v8, 113664, v209
    ds_read_b128 v[148:151], v8
    s_waitcnt lgkmcnt(3)
    buffer_store_dwordx4 v[144:147], v208, s[44:47], s56 offen sc1
    v_lshlrev_b32 v224, 16, v120
    v_and_b32 v225, s4, v120
    v_fma_f32 v52, v52, v194, v224
    v_fma_f32 v53, v53, v194, v225
    v_cvt_pk_bf16_f32 v120, v52, v53
    v_lshlrev_b32 v224, 16, v121
    v_and_b32 v225, s4, v121
    v_fma_f32 v68, v68, v194, v224
    v_fma_f32 v69, v69, v194, v225
    v_cvt_pk_bf16_f32 v121, v68, v69
    v_lshlrev_b32 v224, 16, v122
    v_and_b32 v225, s4, v122
    v_fma_f32 v84, v84, v194, v224
    v_fma_f32 v85, v85, v194, v225
    v_cvt_pk_bf16_f32 v122, v84, v85
    v_lshlrev_b32 v224, 16, v123
    v_and_b32 v225, s4, v123
    v_fma_f32 v100, v100, v194, v224
    v_fma_f32 v101, v101, v194, v225
    v_cvt_pk_bf16_f32 v123, v100, v101
    ds_write2_b32 v202, v120, v121 offset0:0 offset1:32
    ds_write2_b32 v202, v122, v123 offset0:64 offset1:96
    v_add_u32 v8, 113664, v210
    ds_read_b128 v[152:155], v8
    s_waitcnt lgkmcnt(3)
    buffer_store_dwordx4 v[148:151], v209, s[44:47], s56 offen sc1
    v_lshlrev_b32 v224, 16, v124
    v_and_b32 v225, s4, v124
    v_fma_f32 v54, v54, v195, v224
    v_fma_f32 v55, v55, v195, v225
    v_cvt_pk_bf16_f32 v124, v54, v55
    v_lshlrev_b32 v224, 16, v125
    v_and_b32 v225, s4, v125
    v_fma_f32 v70, v70, v195, v224
    v_fma_f32 v71, v71, v195, v225
    v_cvt_pk_bf16_f32 v125, v70, v71
    v_lshlrev_b32 v224, 16, v126
    v_and_b32 v225, s4, v126
    v_fma_f32 v86, v86, v195, v224
    v_fma_f32 v87, v87, v195, v225
    v_cvt_pk_bf16_f32 v126, v86, v87
    v_lshlrev_b32 v224, 16, v127
    v_and_b32 v225, s4, v127
    v_fma_f32 v102, v102, v195, v224
    v_fma_f32 v103, v103, v195, v225
    v_cvt_pk_bf16_f32 v127, v102, v103
    ds_write2_b32 v203, v124, v125 offset0:0 offset1:32
    ds_write2_b32 v203, v126, v127 offset0:64 offset1:96
    v_add_u32 v8, 113664, v211
    ds_read_b128 v[156:159], v8
    s_waitcnt lgkmcnt(3)
    buffer_store_dwordx4 v[152:155], v210, s[44:47], s56 offen sc1
    v_lshlrev_b32 v224, 16, v128
    v_and_b32 v225, s4, v128
    v_fma_f32 v56, v56, v196, v224
    v_fma_f32 v57, v57, v196, v225
    v_cvt_pk_bf16_f32 v128, v56, v57
    v_lshlrev_b32 v224, 16, v129
    v_and_b32 v225, s4, v129
    v_fma_f32 v72, v72, v196, v224
    v_fma_f32 v73, v73, v196, v225
    v_cvt_pk_bf16_f32 v129, v72, v73
    v_lshlrev_b32 v224, 16, v130
    v_and_b32 v225, s4, v130
    v_fma_f32 v88, v88, v196, v224
    v_fma_f32 v89, v89, v196, v225
    v_cvt_pk_bf16_f32 v130, v88, v89
    v_lshlrev_b32 v224, 16, v131
    v_and_b32 v225, s4, v131
    v_fma_f32 v104, v104, v196, v224
    v_fma_f32 v105, v105, v196, v225
    v_cvt_pk_bf16_f32 v131, v104, v105
    ds_write2_b32 v204, v128, v129 offset0:0 offset1:32
    ds_write2_b32 v204, v130, v131 offset0:64 offset1:96
    v_add_u32 v8, 113664, v212
    ds_read_b128 v[160:163], v8
    s_waitcnt lgkmcnt(3)
    buffer_store_dwordx4 v[156:159], v211, s[44:47], s56 offen sc1
    v_lshlrev_b32 v224, 16, v132
    v_and_b32 v225, s4, v132
    v_fma_f32 v58, v58, v197, v224
    v_fma_f32 v59, v59, v197, v225
    v_cvt_pk_bf16_f32 v132, v58, v59
    v_lshlrev_b32 v224, 16, v133
    v_and_b32 v225, s4, v133
    v_fma_f32 v74, v74, v197, v224
    v_fma_f32 v75, v75, v197, v225
    v_cvt_pk_bf16_f32 v133, v74, v75
    v_lshlrev_b32 v224, 16, v134
    v_and_b32 v225, s4, v134
    v_fma_f32 v90, v90, v197, v224
    v_fma_f32 v91, v91, v197, v225
    v_cvt_pk_bf16_f32 v134, v90, v91
    v_lshlrev_b32 v224, 16, v135
    v_and_b32 v225, s4, v135
    v_fma_f32 v106, v106, v197, v224
    v_fma_f32 v107, v107, v197, v225
    v_cvt_pk_bf16_f32 v135, v106, v107
    ds_write2_b32 v205, v132, v133 offset0:0 offset1:32
    ds_write2_b32 v205, v134, v135 offset0:64 offset1:96
    v_add_u32 v8, 113664, v213
    ds_read_b128 v[164:167], v8
    s_waitcnt lgkmcnt(3)
    buffer_store_dwordx4 v[160:163], v212, s[44:47], s56 offen sc1
    v_lshlrev_b32 v224, 16, v136
    v_and_b32 v225, s4, v136
    v_fma_f32 v60, v60, v198, v224
    v_fma_f32 v61, v61, v198, v225
    v_cvt_pk_bf16_f32 v136, v60, v61
    v_lshlrev_b32 v224, 16, v137
    v_and_b32 v225, s4, v137
    v_fma_f32 v76, v76, v198, v224
    v_fma_f32 v77, v77, v198, v225
    v_cvt_pk_bf16_f32 v137, v76, v77
    v_lshlrev_b32 v224, 16, v138
    v_and_b32 v225, s4, v138
    v_fma_f32 v92, v92, v198, v224
    v_fma_f32 v93, v93, v198, v225
    v_cvt_pk_bf16_f32 v138, v92, v93
    v_lshlrev_b32 v224, 16, v139
    v_and_b32 v225, s4, v139
    v_fma_f32 v108, v108, v198, v224
    v_fma_f32 v109, v109, v198, v225
    v_cvt_pk_bf16_f32 v139, v108, v109
    ds_write2_b32 v206, v136, v137 offset0:0 offset1:32
    ds_write2_b32 v206, v138, v139 offset0:64 offset1:96
    v_add_u32 v8, 113664, v214
    ds_read_b128 v[168:171], v8
    s_waitcnt lgkmcnt(3)
    buffer_store_dwordx4 v[164:167], v213, s[44:47], s56 offen sc1
    s_waitcnt lgkmcnt(0)
    buffer_store_dwordx4 v[168:171], v214, s[44:47], s56 offen sc1
    s_cmp_eq_u32 s12, 0
    s_cbranch_scc1 K2_END
    s_waitcnt vmcnt(0)
    s_barrier
    s_add_u32 s11, s11, s10
    s_branch K2_ROUND
K2_RETRY:
    s_mov_b32 s10, 16
    s_waitcnt vmcnt(0) lgkmcnt(0)
    s_barrier
    s_branch K2_ROUND
K2_COLD:
    s_mov_b32 s60, 1
    v_cmp_ne_u32 s[6:7], v16, v17
    s_bcnt1_i32_b64 s8, vcc
    s_cmp_gt_u32 s8, 8
    s_cbranch_scc1 K2_COLDALL
    s_cmp_lg_u64 s[6:7], 0
    s_cbranch_scc1 K2_COLDALL
    s_mov_b64 s[6:7], vcc
    s_mov_b64 exec, 3
K2_COLD1:
    s_ff1_i32_b64 s8, s[6:7]
    s_bitset0_b64 s[6:7], s8
    v_readlane_b32 s9, v17, s8
    s_nop 3
    s_lshl_b32 s9, s9, 5
    s_add_u32 s9, s9, 32736
    s_add_u32 m0, s9, 4096
    s_nop 0
    buffer_load_dwordx4 v7, s[28:31], s9 offen lds
    s_cmp_lg_u64 s[6:7], 0
    s_cbranch_scc1 K2_COLD1
    s_mov_b64 exec, -1
    s_branch K2_NOCOLD
K2_COLDALL:
    s_mov_b32 s9, 32768
K2_COLD2:
    s_add_u32 m0, s9, 4096
    s_nop 0
    buffer_load_dwordx4 v7, s[28:31], s9 offen lds
    s_add_u32 s9, s9, 1024
    s_cmp_lt_u32 s9, 73728
    s_cbranch_scc1 K2_COLD2
    s_branch K2_NOCOLD
K2_FA0:
    s_cmp_eq_u32 s61, 0
    s_cbranch_scc1 K2_FR0
    v_mad_u32_u16 v26, v28, 32, v1 op_sel:[0,0,0,0]
    buffer_load_dwordx4 v[144:147], v26, s[36:39], 0 idxen
    buffer_load_dword v184, v26, s[48:51], 0 idxen
    s_branch K2_FR0
K2_FA1:
    s_cmp_eq_u32 s61, 0
    s_cbranch_scc1 K2_FR1
    v_mad_u32_u16 v27, v28, 32, v1 op_sel:[1,0,0,0]
    buffer_load_dwordx4 v[148:151], v27, s[36:39], 0 idxen
    buffer_load_dword v185, v27, s[48:51], 0 idxen
    s_branch K2_FR1
K2_FA2:
    s_cmp_eq_u32 s61, 0
    s_cbranch_scc1 K2_FR2
    v_mad_u32_u16 v26, v29, 32, v1 op_sel:[0,0,0,0]
    buffer_load_dwordx4 v[152:155], v26, s[36:39], 0 idxen
    buffer_load_dword v186, v26, s[48:51], 0 idxen
    s_branch K2_FR2
K2_FA3:
    s_cmp_eq_u32 s61, 0
    s_cbranch_scc1 K2_FR3
    v_mad_u32_u16 v27, v29, 32, v1 op_sel:[1,0,0,0]
    buffer_load_dwordx4 v[156:159], v27, s[36:39], 0 idxen
    buffer_load_dword v187, v27, s[48:51], 0 idxen
    s_branch K2_FR3
K2_FA4:
    s_cmp_eq_u32 s61, 0
    s_cbranch_scc1 K2_FR4
    v_mad_u32_u16 v26, v30, 32, v1 op_sel:[0,0,0,0]
    buffer_load_dwordx4 v[160:163], v26, s[36:39], 0 idxen
    buffer_load_dword v188, v26, s[48:51], 0 idxen
    s_branch K2_FR4
K2_FA5:
    s_cmp_eq_u32 s61, 0
    s_cbranch_scc1 K2_FR5
    v_mad_u32_u16 v27, v30, 32, v1 op_sel:[1,0,0,0]
    buffer_load_dwordx4 v[164:167], v27, s[36:39], 0 idxen
    buffer_load_dword v189, v27, s[48:51], 0 idxen
    s_branch K2_FR5
K2_FA6:
    s_cmp_eq_u32 s61, 0
    s_cbranch_scc1 K2_FR6
    v_mad_u32_u16 v26, v31, 32, v1 op_sel:[0,0,0,0]
    buffer_load_dwordx4 v[168:171], v26, s[36:39], 0 idxen
    buffer_load_dword v190, v26, s[48:51], 0 idxen
    s_branch K2_FR6
K2_FA7:
    s_cmp_eq_u32 s61, 0
    s_cbranch_scc1 K2_FR7
    v_mad_u32_u16 v27, v31, 32, v1 op_sel:[1,0,0,0]
    buffer_load_dwordx4 v[172:175], v27, s[36:39], 0 idxen
    buffer_load_dword v191, v27, s[48:51], 0 idxen
    s_branch K2_FR7
K2_HALF:
    s_cmp_eq_u32 s57, 0
    s_cbranch_scc1 K2_NOHALF
    ds_read_b128 v[12:15], v4 offset:448
    ds_read_b128 v[28:31], v4 offset:160
    ds_read_b128 v[36:39], v4 offset:288
    ds_read_b128 v[40:43], v4 offset:352
    ds_read_b128 v[44:47], v4 offset:416
    ds_read_b128 v[32:35], v4 offset:224
    s_nop 7
    v_cvt_pk_f16_f32 v232, v232, v248
    v_cvt_pk_f16_f32 v233, v233, v249
    v_cvt_pk_f16_f32 v234, v234, v250
    v_cvt_pk_f16_f32 v235, v235, v251
    v_cvt_pk_f16_f32 v236, v236, v252
    v_cvt_pk_f16_f32 v237, v237, v253
    v_cvt_pk_f16_f32 v238, v238, v254
    v_cvt_pk_f16_f32 v239, v239, v255
    s_waitcnt lgkmcnt(4)
    v_pk_lshlrev_b16 v28, v2, v28
    v_pk_lshlrev_b16 v29, v2, v29
    s_branch K2_HRET
K2_ESLOW:
    v_ldexp_f32 v48, v48, v192
    v_ldexp_f32 v49, v49, v192
    v_ldexp_f32 v64, v64, v192
    v_ldexp_f32 v65, v65, v192
    v_ldexp_f32 v80, v80, v192
    v_ldexp_f32 v81, v81, v192
    v_ldexp_f32 v96, v96, v192
    v_ldexp_f32 v97, v97, v192
    v_ldexp_f32 v50, v50, v193
    v_ldexp_f32 v51, v51, v193
    v_ldexp_f32 v66, v66, v193
    v_ldexp_f32 v67, v67, v193
    v_ldexp_f32 v82, v82, v193
    v_ldexp_f32 v83, v83, v193
    v_ldexp_f32 v98, v98, v193
    v_ldexp_f32 v99, v99, v193
    v_ldexp_f32 v52, v52, v194
    v_ldexp_f32 v53, v53, v194
    v_ldexp_f32 v68, v68, v194
    v_ldexp_f32 v69, v69, v194
    v_ldexp_f32 v84, v84, v194
    v_ldexp_f32 v85, v85, v194
    v_ldexp_f32 v100, v100, v194
    v_ldexp_f32 v101, v101, v194
    v_ldexp_f32 v54, v54, v195
    v_ldexp_f32 v55, v55, v195
    v_ldexp_f32 v70, v70, v195
    v_ldexp_f32 v71, v71, v195
    v_ldexp_f32 v86, v86, v195
    v_ldexp_f32 v87, v87, v195
    v_ldexp_f32 v102, v102, v195
    v_ldexp_f32 v103, v103, v195
    v_ldexp_f32 v56, v56, v196
    v_ldexp_f32 v57, v57, v196
    v_ldexp_f32 v72, v72, v196
    v_ldexp_f32 v73, v73, v196
    v_ldexp_f32 v88, v88, v196
    v_ldexp_f32 v89, v89, v196
    v_ldexp_f32 v104, v104, v196
    v_ldexp_f32 v105, v105, v196
    v_ldexp_f32 v58, v58, v197
    v_ldexp_f32 v59, v59, v197
    v_ldexp_f32 v74, v74, v197
    v_ldexp_f32 v75, v75, v197
    v_ldexp_f32 v90, v90, v197
    v_ldexp_f32 v91, v91, v197
    v_ldexp_f32 v106, v106, v197
    v_ldexp_f32 v107, v107, v197
    v_ldexp_f32 v60, v60, v198
    v_ldexp_f32 v61, v61, v198
    v_ldexp_f32 v76, v76, v198
    v_ldexp_f32 v77, v77, v198
    v_ldexp_f32 v92, v92, v198
    v_ldexp_f32 v93, v93, v198
    v_ldexp_f32 v108, v108, v198
    v_ldexp_f32 v109, v109, v198
    v_mov_b32 v192, 0
    v_mov_b32 v193, 0
    v_mov_b32 v194, 0
    v_mov_b32 v195, 0
    v_mov_b32 v196, 0
    v_mov_b32 v197, 0
    v_mov_b32 v198, 0
    s_branch K2_EBACK
K2_END:
    s_endpgm
.section .rodata,"a"
.p2align 6
.amdhsa_kernel painn_prep_kernel
  .amdhsa_next_free_vgpr 128
  .amdhsa_next_free_sgpr 80
  .amdhsa_accum_offset 128
  .amdhsa_group_segment_fixed_size 0
  .amdhsa_kernarg_size 88
  .amdhsa_user_sgpr_count 2
  .amdhsa_user_sgpr_kernarg_segment_ptr 1
  .amdhsa_system_sgpr_workgroup_id_x 1
  .amdhsa_float_denorm_mode_32 3
.end_amdhsa_kernel
.p2align 6
.amdhsa_kernel painn_main_kernel
  .amdhsa_next_free_vgpr 256
  .amdhsa_next_free_sgpr 92
  .amdhsa_accum_offset 256
  .amdhsa_group_segment_fixed_size 0
  .amdhsa_kernarg_size 88
  .amdhsa_user_sgpr_count 2
  .amdhsa_user_sgpr_kernarg_segment_ptr 1
  .amdhsa_system_sgpr_workgroup_id_x 1
  .amdhsa_float_denorm_mode_32 3
.end_amdhsa_kernel
```
